```python
import torch

def _softmax(x, axis=-1):
    return torch.softmax(x, dim=axis)
def _gelu(x):
    return torch.nn.functional.gelu(x, approximate="tanh")
def _silu(x):
    return torch.nn.functional.silu(x)
def _sigmoid(x):
    return torch.sigmoid(x)
def _layernorm(x, axis=-1, eps=1e-5):
    m = x.mean(dim=axis, keepdim=True)
    v = x.var(dim=axis, keepdim=True, unbiased=False)
    return (x - m) / torch.sqrt(v + eps)
def _scatter_add(tgt, idx, src, axis=0):
    return tgt.clone().index_add_(axis, idx, src)
def _segment_sum(src, seg, n):
    out = torch.zeros((n,) + src.shape[1:], dtype=src.dtype)
    return out.index_add_(0, seg, src)
def _pad(x, pw):
    flat = tuple(v for pair in reversed(pw) for v in pair)
    return torch.nn.functional.pad(x, flat)

kernel_name = 'gated_mix__ssm_conv_s4__swiglu_ffn__prompt'

def setup_inputs():

    _w = (lambda a: (lambda t: t.to(torch.bfloat16) if t.is_floating_point() else t)(torch.as_tensor(a)))
    def _A_setup():
        B, L, D, N = 1, 2048, 640, 192
        A_re = -(lambda _x: torch.exp(torch.as_tensor(_x)))((lambda *s: torch.randn(*s, dtype=torch.bfloat16) * 3.2)(D, N))
        A_im = torch.pi * (lambda *s: torch.randn(*s, dtype=torch.bfloat16) * 0.05)(D, N)
        B_re = (lambda *s: torch.randn(*s, dtype=torch.bfloat16) * 0.1)(D, N)
        B_im = (lambda *s: torch.randn(*s, dtype=torch.bfloat16) * 0.1)(D, N)
        C_re = (lambda *s: torch.randn(*s, dtype=torch.bfloat16) * 0.1)(D, N)
        C_im = (lambda *s: torch.randn(*s, dtype=torch.bfloat16) * 0.1)(D, N)
        log_dt = (lambda *s: torch.randn(*s, dtype=torch.bfloat16) * 0.05)(D) * 0.5 - 4.0
        Dskip = (lambda *s: torch.randn(*s, dtype=torch.bfloat16) * 0.05)(D)
        return {
            "u": _w((lambda *s: torch.randn(*s, dtype=torch.bfloat16) * 0.05)(B, L, D)),
            "A_re": _w(A_re),
            "A_im": _w(A_im),
            "B_re": _w(B_re),
            "B_im": _w(B_im),
            "C_re": _w(C_re),
            "C_im": _w(C_im),
            "log_dt": _w(log_dt),
            "Dskip": _w(Dskip),
        }
    _A_in = _A_setup()

    def _B_setup():
        B, S, D, F = 1, 2048, 640, 1536
        return {
            "x": _w((lambda *s: torch.randn(*s, dtype=torch.bfloat16) * 0.05)(B, S, D)),
            "w_gate": _w((lambda *s: torch.randn(*s, dtype=torch.bfloat16) * 0.05)(D, F)),
            "w_up": _w((lambda *s: torch.randn(*s, dtype=torch.bfloat16) * 0.05)(D, F)),
            "w_down": _w((lambda *s: torch.randn(*s, dtype=torch.bfloat16) * 0.05)(F, D)),
        }
    _B_in = _B_setup()

    return {
        "A_u": _A_in["u"],
        "A_A_re": _A_in["A_re"],
        "A_A_im": _A_in["A_im"],
        "A_B_re": _A_in["B_re"],
        "A_B_im": _A_in["B_im"],
        "A_C_re": _A_in["C_re"],
        "A_C_im": _A_in["C_im"],
        "A_log_dt": _A_in["log_dt"],
        "A_Dskip": _A_in["Dskip"],
        "B_x": _B_in["x"],
        "B_w_gate": _B_in["w_gate"],
        "B_w_up": _B_in["w_up"],
        "B_w_down": _B_in["w_down"],
        "gate_w": _w((lambda *s: torch.randn(*s, dtype=torch.bfloat16) * 0.05)(640) * 16.0),
    }

def reference(A_u, A_A_re, A_A_im, A_B_re, A_B_im, A_C_re, A_C_im, A_log_dt, A_Dskip, B_x, B_w_gate, B_w_up, B_w_down, gate_w):
    def _A_ref(u, A_re, A_im, B_re, B_im, C_re, C_im, log_dt, Dskip):
        Bsz, L, D = u.shape
        dt = torch.exp(log_dt)[:, None]
        A = A_re + 1j * A_im
        Bc = B_re + 1j * B_im
        Cc = C_re + 1j * C_im
        logdA = dt * A
        dB = dt * Bc
        l = (lambda x, dt: x.to(dt))(torch.arange(L), A_re.dtype)
        P = torch.exp(logdA[:, :, None] * l[None, None, :])
        K = torch.einsum("dn,dnl,dn->dl", Cc, P, dB).real
        L2 = 2 * L
        Kp = _pad(K, ((0, 0), (0, L)))
        up = (lambda x, *d: x.permute(*d))(u, 0, 2, 1)
        up = _pad(up, ((0, 0), (0, 0), (0, L)))
        Kf = (lambda x, axes=(-2,-1): torch.fft.rfft2(x.float(), dim=axes))(Kp[:, None, :], axes=(-2, -1))
        Uf = (lambda x, axes=(-2,-1): torch.fft.rfft2(x.float(), dim=axes))(up[:, :, None, :], axes=(-2, -1))
        Yf = Uf * Kf[None, :, :, :]
        y = (lambda x, s, axes=(-2,-1): torch.fft.irfft2(x, s=s, dim=axes).to(torch.bfloat16))(Yf, (1, L2), axes=(-2, -1))[:, :, 0, :L]
        y = (lambda x, *d: x.permute(*d))(y, 0, 2, 1) + u * Dskip[None, None, :]
        return y

    def _B_ref(x, w_gate, w_up, w_down):
        g = _silu(x @ w_gate)
        u = x @ w_up
        return (g * u) @ w_down

    x = A_u
    g = _sigmoid((x * gate_w).sum(-1, keepdims=True))
    a = _A_ref(x, A_A_re, A_A_im, A_B_re, A_B_im, A_C_re, A_C_im, A_log_dt, A_Dskip)
    b = _B_ref(x, B_w_gate, B_w_up, B_w_down)
    return g * a + (1 - g) * b
```

```asm
; @launch grid=(256,1,1) block=(512,1,1) lds=163840
.amdgcn_target "amdgcn-amd-amdhsa--gfx950"
.text
.globl gated_mix__ssm_conv_s4__swiglu_ffn__prompt_kernel
.p2align 8
.type gated_mix__ssm_conv_s4__swiglu_ffn__prompt_kernel,@function
gated_mix__ssm_conv_s4__swiglu_ffn__prompt_kernel:
    s_cmp_ge_u32 s2, 256
    s_cbranch_scc1 gated_mix__ssm_conv_s4__swiglu_ffn__prompt_kernel_end
    s_load_dwordx16 s[32:47], s[0:1], 0
    s_load_dwordx16 s[48:63], s[0:1], 64
    s_load_dwordx2 s[64:65], s[0:1], 128
    s_getpc_b64 s[68:69]
L_gated__pc_1:
    s_sub_u32 s68, s68, L_gated__pc_1-gated_mix__ssm_conv_s4__swiglu_ffn__prompt_kernel
    s_subb_u32 s69, s69, 0
    s_mov_b32 s67, (gated_mix__ssm_conv_s4__swiglu_ffn__prompt_kernel_end-gated_mix__ssm_conv_s4__swiglu_ffn__prompt_kernel+4095)/4096
    s_lshr_b32 s70, s2, 3
    s_mul_i32 s70, s70, s67
    v_add_u32 v1, s70, v0
    v_lshlrev_b32 v1, 7, v1
    v_min_u32 v1, gated_mix__ssm_conv_s4__swiglu_ffn__prompt_kernel_end-gated_mix__ssm_conv_s4__swiglu_ffn__prompt_kernel, v1
    v_cmp_gt_u32 vcc, s67, v0
    s_and_saveexec_b64 s[70:71], vcc
    s_cbranch_execz L_gated__pc_2
    global_load_dword v244, v1, s[68:69]
L_gated__pc_2:
    s_mov_b64 exec, s[70:71]
    v_lshrrev_b32 v1, 6, v0
    v_and_b32 v0, 63, v0
    v_readfirstlane_b32 s3, v1
    s_and_b32 s66, s2, 7
    s_lshr_b32 s67, s2, 3
    s_and_b32 s68, s67, 7
    s_lshr_b32 s69, s67, 3
    s_and_b32 s70, s66, 1
    s_lshl_b32 s70, s70, 3
    s_or_b32 s4, s70, s68
    s_lshr_b32 s70, s66, 1
    s_lshl_b32 s70, s70, 2
    s_or_b32 s5, s70, s69
    s_and_b32 s70, s66, 3
    s_lshl_b32 s70, s70, 3
    s_or_b32 s6, s70, s68
    s_lshr_b32 s70, s66, 2
    s_lshl_b32 s70, s70, 2
    s_or_b32 s7, s70, s69
    s_cmp_ge_u32 s3, 4
    s_cbranch_scc1 gated_mix__ssm_conv_s4__swiglu_ffn__prompt_kernel_S
    v_mov_b32 v197, v0
    s_and_b32 s67, s3, 1
    s_lshr_b32 s68, s3, 1
    v_lshrrev_b32 v200, 3, v197
    s_lshl_b32 s69, s4, 7
    s_lshl_b32 s70, s3, 5
    s_add_u32 s69, s69, s70
    v_add_u32 v200, s69, v200
    s_movk_i32 s70, 1280
    v_mul_lo_u32 v200, v200, s70
    v_and_b32 v201, 7, v197
    v_lshrrev_b32 v202, 4, v197
    v_xor_b32 v203, v201, v202
    v_xor_b32 v204, 4, v203
    v_lshl_add_u32 v191, v203, 4, v200
    v_lshl_add_u32 v192, v204, 4, v200
    s_lshl_b32 s75, s3, 12
    s_mul_i32 s76, s3, 3072
    s_add_u32 s77, s76, 28672
    s_add_u32 s76, s76, 16384
    s_lshr_b32 s74, s5, 1
    s_cmp_ge_u32 s74, 5
    s_cselect_b32 s72, 1, 0
    s_cmp_ge_u32 s74, 1
    s_addc_u32 s74, s74, s72
    s_lshl_b32 s69, s3, 4
    s_mul_i32 s69, s69, 3072
    s_mul_i32 s70, s5, 192
    s_add_u32 s69, s69, s70
    s_mov_b32 s70, 43691
    s_movk_i32 s71, 3072
    v_add_u32 v200, 0, v197
    v_mul_lo_u32 v201, v200, s70
    v_lshrrev_b32 v201, 19, v201
    v_mul_u32_u24 v202, 12, v201
    v_sub_u32 v202, v200, v202
    v_lshrrev_b32 v203, 2, v201
    v_and_b32 v203, 2, v203
    v_xor_b32 v202, v202, v203
    v_mul_lo_u32 v201, v201, s71
    v_lshl_add_u32 v201, v202, 4, v201
    v_add_u32 v201, s69, v201
    v_subrev_u32 v193, 0, v201
    v_add_u32 v200, 64, v197
    v_mul_lo_u32 v201, v200, s70
    v_lshrrev_b32 v201, 19, v201
    v_mul_u32_u24 v202, 12, v201
    v_sub_u32 v202, v200, v202
    v_lshrrev_b32 v203, 2, v201
    v_and_b32 v203, 2, v203
    v_xor_b32 v202, v202, v203
    v_mul_lo_u32 v201, v201, s71
    v_lshl_add_u32 v201, v202, 4, v201
    v_add_u32 v201, s69, v201
    v_subrev_u32 v194, 1024, v201
    v_add_u32 v200, 128, v197
    v_mul_lo_u32 v201, v200, s70
    v_lshrrev_b32 v201, 19, v201
    v_mul_u32_u24 v202, 12, v201
    v_sub_u32 v202, v200, v202
    v_lshrrev_b32 v203, 2, v201
    v_and_b32 v203, 2, v203
    v_xor_b32 v202, v202, v203
    v_mul_lo_u32 v201, v201, s71
    v_lshl_add_u32 v201, v202, 4, v201
    v_add_u32 v201, s69, v201
    v_subrev_u32 v195, 2048, v201
    s_waitcnt lgkmcnt(0)
    s_mov_b32 s8, s32
    s_and_b32 s9, s33, 0xffff
    s_mov_b32 s10, 0x280000
    s_mov_b32 s11, 0x20000
    s_mov_b32 s12, s52
    s_and_b32 s13, s53, 0xffff
    s_mov_b32 s14, 0x1e0000
    s_mov_b32 s15, 0x20000
    s_mov_b32 s16, s54
    s_and_b32 s17, s55, 0xffff
    s_mov_b32 s18, 0x1e0000
    s_mov_b32 s19, 0x20000
    s_lshl_b32 s72, s74, 7
    s_mul_i32 s73, s74, 196608
    s_add_u32 s74, s74, 1
    s_add_u32 m0, s75, 0
    s_cmp_eq_u32 s74, 10
    s_cselect_b32 s74, 0, s74
    buffer_load_dwordx4 v191, s[8:11], s72 offen lds
    s_add_u32 s70, s72, 9216
    buffer_load_dwordx4 v192, s[8:11], s70 offen offset:1024 lds
    s_add_u32 s70, s72, 18432
    buffer_load_dwordx4 v191, s[8:11], s70 offen offset:2048 lds
    s_add_u32 s70, s72, 27648
    buffer_load_dwordx4 v192, s[8:11], s70 offen offset:3072 lds
    s_add_u32 m0, s76, 0
    s_nop 0
    buffer_load_dwordx4 v193, s[12:15], s73 offen offset:0 lds
    buffer_load_dwordx4 v194, s[12:15], s73 offen offset:1024 lds
    buffer_load_dwordx4 v195, s[12:15], s73 offen offset:2048 lds
    s_add_u32 m0, s77, 0
    s_nop 0
    buffer_load_dwordx4 v193, s[16:19], s73 offen offset:0 lds
    buffer_load_dwordx4 v194, s[16:19], s73 offen offset:1024 lds
    buffer_load_dwordx4 v195, s[16:19], s73 offen offset:2048 lds
    s_lshl_b32 s72, s74, 7
    s_mul_i32 s73, s74, 196608
    s_add_u32 s74, s74, 1
    s_add_u32 m0, s75, 40960
    s_cmp_eq_u32 s74, 10
    s_cselect_b32 s74, 0, s74
    buffer_load_dwordx4 v191, s[8:11], s72 offen lds
    s_add_u32 s70, s72, 9216
    buffer_load_dwordx4 v192, s[8:11], s70 offen offset:1024 lds
    s_add_u32 s70, s72, 18432
    buffer_load_dwordx4 v191, s[8:11], s70 offen offset:2048 lds
    s_add_u32 s70, s72, 27648
    buffer_load_dwordx4 v192, s[8:11], s70 offen offset:3072 lds
    s_add_u32 m0, s76, 40960
    s_nop 0
    buffer_load_dwordx4 v193, s[12:15], s73 offen offset:0 lds
    buffer_load_dwordx4 v194, s[12:15], s73 offen offset:1024 lds
    buffer_load_dwordx4 v195, s[12:15], s73 offen offset:2048 lds
    s_add_u32 m0, s77, 40960
    s_nop 0
    buffer_load_dwordx4 v193, s[16:19], s73 offen offset:0 lds
    buffer_load_dwordx4 v194, s[16:19], s73 offen offset:1024 lds
    buffer_load_dwordx4 v195, s[16:19], s73 offen offset:2048 lds
    s_mov_b32 s20, s64
    s_and_b32 s21, s65, 0xffff
    s_mov_b32 s22, 0x10000000
    s_mov_b32 s23, 0x20000
    s_mov_b32 s24, s60
    s_and_b32 s25, s61, 0xffff
    s_mov_b32 s26, 0x280000
    s_mov_b32 s27, 0x20000
    s_mov_b32 s28, s56
    s_and_b32 s29, s57, 0xffff
    s_mov_b32 s30, 0x1e0000
    s_mov_b32 s31, 0x20000
    v_and_b32 v200, 15, v197
    v_lshrrev_b32 v201, 4, v197
    s_lshl_b32 s69, s67, 6
    v_add_u32 v202, s69, v200
    v_lshlrev_b32 v202, 7, v202
    v_lshrrev_b32 v203, 1, v200
    v_and_b32 v203, 7, v203
    v_xor_b32 v203, v203, v201
    v_xor_b32 v204, 4, v203
    v_lshl_add_u32 v176, v203, 4, v202
    v_lshl_add_u32 v177, v204, 4, v202
    v_add_u32 v178, 40960, v176
    v_add_u32 v179, 40960, v177
    v_add_u32 v180, 81920, v176
    v_add_u32 v181, 81920, v177
    v_lshrrev_b32 v202, 2, v200
    v_lshl_add_u32 v202, v201, 3, v202
    v_mul_u32_u24 v202, 192, v202
    v_and_b32 v203, 3, v197
    v_lshl_add_u32 v202, v203, 3, v202
    v_add_u32 v202, 16384, v202
    v_and_b32 v203, 1, v201
    s_lshl_b32 s69, s68, 2
    s_add_u32 s78, s69, 1
    s_add_u32 s79, s68, 2
    v_xor_b32 v204, s69, v203
    v_lshl_add_u32 v182, v204, 5, v202
    v_xor_b32 v204, s78, v203
    v_lshl_add_u32 v183, v204, 5, v202
    v_xor_b32 v204, s79, v203
    v_lshl_add_u32 v184, v204, 5, v202
    v_add_u32 v185, 40960, v182
    v_add_u32 v186, 40960, v183
    v_add_u32 v187, 40960, v184
    v_add_u32 v188, 81920, v182
    v_add_u32 v189, 81920, v183
    v_add_u32 v190, 81920, v184
    v_lshlrev_b32 v196, 4, v197
    s_lshl_b32 s69, s4, 1
    s_add_u32 s69, s69, s67
    s_mul_i32 s69, s69, 48
    s_mul_i32 s78, s5, 3
    s_add_u32 s69, s69, s78
    s_lshl_b32 s78, s68, 1
    s_add_u32 s78, s78, s69
    s_lshl_b32 s78, s78, 12
    s_add_u32 s79, s69, 1
    s_lshl_b32 s79, s79, 12
    s_lshl_b32 s69, s68, 9
    s_add_u32 s79, s79, s69
    v_lshlrev_b32 v198, 3, v197
    s_waitcnt vmcnt(10)
    s_barrier
    ds_read_b128 v[96:99], v176 offset:0
    ds_read_b64_tr_b16 v[112:113], v182 offset:0
    ds_read_b64_tr_b16 v[114:115], v182 offset:768
    ds_read_b128 v[100:103], v176 offset:2048
    ds_read_b64_tr_b16 v[124:125], v182 offset:12288
    ds_read_b64_tr_b16 v[126:127], v182 offset:13056
    ds_read_b128 v[104:107], v176 offset:4096
    ds_read_b128 v[108:111], v176 offset:6144
    ds_read_b64_tr_b16 v[116:117], v183 offset:0
    ds_read_b64_tr_b16 v[118:119], v183 offset:768
    ds_read_b64_tr_b16 v[120:121], v184 offset:0
    ds_read_b64_tr_b16 v[122:123], v184 offset:768
    ds_read_b64_tr_b16 v[128:129], v183 offset:12288
    ds_read_b64_tr_b16 v[130:131], v183 offset:13056
    ds_read_b64_tr_b16 v[132:133], v184 offset:12288
    ds_read_b64_tr_b16 v[134:135], v184 offset:13056
    s_waitcnt lgkmcnt(0)
    v_mfma_f32_16x16x32_bf16 v[0:3], v[112:115], v[96:99], 0
    ds_read_b128 v[136:139], v177 offset:0
    v_mfma_f32_16x16x32_bf16 v[4:7], v[112:115], v[100:103], 0
    s_lshl_b32 s72, s74, 7
    s_mul_i32 s73, s74, 196608
    s_add_u32 s74, s74, 1
    s_add_u32 m0, s75, 81920
    s_cmp_eq_u32 s74, 10
    s_cselect_b32 s74, 0, s74
    buffer_load_dwordx4 v191, s[8:11], s72 offen lds
    ds_read_b64_tr_b16 v[152:153], v182 offset:6144
    v_mfma_f32_16x16x32_bf16 v[8:11], v[112:115], v[104:107], 0
    ds_read_b64_tr_b16 v[154:155], v182 offset:6912
    v_mfma_f32_16x16x32_bf16 v[12:15], v[112:115], v[108:111], 0
    s_add_u32 s70, s72, 9216
    buffer_load_dwordx4 v192, s[8:11], s70 offen offset:1024 lds
    ds_read_b128 v[140:143], v177 offset:2048
    v_mfma_f32_16x16x32_bf16 v[48:51], v[124:127], v[96:99], 0
    ds_read_b64_tr_b16 v[164:165], v182 offset:18432
    v_mfma_f32_16x16x32_bf16 v[52:55], v[124:127], v[100:103], 0
    s_add_u32 s70, s72, 18432
    buffer_load_dwordx4 v191, s[8:11], s70 offen offset:2048 lds
    ds_read_b64_tr_b16 v[166:167], v182 offset:19200
    v_mfma_f32_16x16x32_bf16 v[56:59], v[124:127], v[104:107], 0
    ds_read_b128 v[144:147], v177 offset:4096
    v_mfma_f32_16x16x32_bf16 v[60:63], v[124:127], v[108:111], 0
    s_add_u32 s70, s72, 27648
    buffer_load_dwordx4 v192, s[8:11], s70 offen offset:3072 lds
    ds_read_b128 v[148:151], v177 offset:6144
    v_mfma_f32_16x16x32_bf16 v[16:19], v[116:119], v[96:99], 0
    ds_read_b64_tr_b16 v[156:157], v183 offset:6144
    v_mfma_f32_16x16x32_bf16 v[20:23], v[116:119], v[100:103], 0
    s_add_u32 m0, s76, 81920
    s_nop 0
    buffer_load_dwordx4 v193, s[12:15], s73 offen offset:0 lds
    ds_read_b64_tr_b16 v[158:159], v183 offset:6912
    v_mfma_f32_16x16x32_bf16 v[24:27], v[116:119], v[104:107], 0
    ds_read_b64_tr_b16 v[160:161], v184 offset:6144
    v_mfma_f32_16x16x32_bf16 v[28:31], v[116:119], v[108:111], 0
    buffer_load_dwordx4 v194, s[12:15], s73 offen offset:1024 lds
    ds_read_b64_tr_b16 v[162:163], v184 offset:6912
    v_mfma_f32_16x16x32_bf16 v[64:67], v[128:131], v[96:99], 0
    ds_read_b64_tr_b16 v[168:169], v183 offset:18432
    v_mfma_f32_16x16x32_bf16 v[68:71], v[128:131], v[100:103], 0
    buffer_load_dwordx4 v195, s[12:15], s73 offen offset:2048 lds
    ds_read_b64_tr_b16 v[170:171], v183 offset:19200
    v_mfma_f32_16x16x32_bf16 v[72:75], v[128:131], v[104:107], 0
    ds_read_b64_tr_b16 v[172:173], v184 offset:18432
    v_mfma_f32_16x16x32_bf16 v[76:79], v[128:131], v[108:111], 0
    s_add_u32 m0, s77, 81920
    s_nop 0
    buffer_load_dwordx4 v193, s[16:19], s73 offen offset:0 lds
    ds_read_b64_tr_b16 v[174:175], v184 offset:19200
    v_mfma_f32_16x16x32_bf16 v[32:35], v[120:123], v[96:99], 0
    v_mfma_f32_16x16x32_bf16 v[36:39], v[120:123], v[100:103], 0
    buffer_load_dwordx4 v194, s[16:19], s73 offen offset:1024 lds
    v_mfma_f32_16x16x32_bf16 v[40:43], v[120:123], v[104:107], 0
    v_mfma_f32_16x16x32_bf16 v[44:47], v[120:123], v[108:111], 0
    buffer_load_dwordx4 v195, s[16:19], s73 offen offset:2048 lds
    v_mfma_f32_16x16x32_bf16 v[80:83], v[132:135], v[96:99], 0
    v_mfma_f32_16x16x32_bf16 v[84:87], v[132:135], v[100:103], 0
    v_mfma_f32_16x16x32_bf16 v[88:91], v[132:135], v[104:107], 0
    v_mfma_f32_16x16x32_bf16 v[92:95], v[132:135], v[108:111], 0
    s_waitcnt vmcnt(10) lgkmcnt(0)
    s_barrier
    v_mfma_f32_16x16x32_bf16 v[0:3], v[152:155], v[136:139], v[0:3]
    ds_read_b128 v[96:99], v178 offset:0
    v_mfma_f32_16x16x32_bf16 v[4:7], v[152:155], v[140:143], v[4:7]
    s_lshl_b32 s72, s74, 7
    s_mul_i32 s73, s74, 196608
    s_add_u32 s74, s74, 1
    s_add_u32 m0, s75, 0
    s_cmp_eq_u32 s74, 10
    s_cselect_b32 s74, 0, s74
    buffer_load_dwordx4 v191, s[8:11], s72 offen lds
    ds_read_b64_tr_b16 v[112:113], v185 offset:0
    v_mfma_f32_16x16x32_bf16 v[8:11], v[152:155], v[144:147], v[8:11]
    ds_read_b64_tr_b16 v[114:115], v185 offset:768
    v_mfma_f32_16x16x32_bf16 v[12:15], v[152:155], v[148:151], v[12:15]
    ds_read_b128 v[100:103], v178 offset:2048
    v_mfma_f32_16x16x32_bf16 v[48:51], v[164:167], v[136:139], v[48:51]
    ds_read_b64_tr_b16 v[124:125], v185 offset:12288
    v_mfma_f32_16x16x32_bf16 v[52:55], v[164:167], v[140:143], v[52:55]
    ds_read_b64_tr_b16 v[126:127], v185 offset:13056
    v_mfma_f32_16x16x32_bf16 v[56:59], v[164:167], v[144:147], v[56:59]
    s_add_u32 s70, s72, 9216
    buffer_load_dwordx4 v192, s[8:11], s70 offen offset:1024 lds
    ds_read_b128 v[104:107], v178 offset:4096
    v_mfma_f32_16x16x32_bf16 v[60:63], v[164:167], v[148:151], v[60:63]
    ds_read_b128 v[108:111], v178 offset:6144
    v_mfma_f32_16x16x32_bf16 v[16:19], v[156:159], v[136:139], v[16:19]
    ds_read_b64_tr_b16 v[116:117], v186 offset:0
    v_mfma_f32_16x16x32_bf16 v[20:23], v[156:159], v[140:143], v[20:23]
    ds_read_b64_tr_b16 v[118:119], v186 offset:768
    v_mfma_f32_16x16x32_bf16 v[24:27], v[156:159], v[144:147], v[24:27]
    ds_read_b64_tr_b16 v[120:121], v187 offset:0
    v_mfma_f32_16x16x32_bf16 v[28:31], v[156:159], v[148:151], v[28:31]
    s_add_u32 s70, s72, 18432
    buffer_load_dwordx4 v191, s[8:11], s70 offen offset:2048 lds
    ds_read_b64_tr_b16 v[122:123], v187 offset:768
    v_mfma_f32_16x16x32_bf16 v[64:67], v[168:171], v[136:139], v[64:67]
    ds_read_b64_tr_b16 v[128:129], v186 offset:12288
    v_mfma_f32_16x16x32_bf16 v[68:71], v[168:171], v[140:143], v[68:71]
    ds_read_b64_tr_b16 v[130:131], v186 offset:13056
    v_mfma_f32_16x16x32_bf16 v[72:75], v[168:171], v[144:147], v[72:75]
    ds_read_b64_tr_b16 v[132:133], v187 offset:12288
    v_mfma_f32_16x16x32_bf16 v[76:79], v[168:171], v[148:151], v[76:79]
    ds_read_b64_tr_b16 v[134:135], v187 offset:13056
    v_mfma_f32_16x16x32_bf16 v[32:35], v[160:163], v[136:139], v[32:35]
    s_add_u32 s70, s72, 27648
    buffer_load_dwordx4 v192, s[8:11], s70 offen offset:3072 lds
    v_mfma_f32_16x16x32_bf16 v[36:39], v[160:163], v[140:143], v[36:39]
    v_mfma_f32_16x16x32_bf16 v[40:43], v[160:163], v[144:147], v[40:43]
    v_mfma_f32_16x16x32_bf16 v[44:47], v[160:163], v[148:151], v[44:47]
    v_mfma_f32_16x16x32_bf16 v[80:83], v[172:175], v[136:139], v[80:83]
    v_mfma_f32_16x16x32_bf16 v[84:87], v[172:175], v[140:143], v[84:87]
    s_add_u32 m0, s76, 0
    s_nop 0
    buffer_load_dwordx4 v193, s[12:15], s73 offen offset:0 lds
    v_mfma_f32_16x16x32_bf16 v[88:91], v[172:175], v[144:147], v[88:91]
    v_mfma_f32_16x16x32_bf16 v[92:95], v[172:175], v[148:151], v[92:95]
    s_waitcnt lgkmcnt(0)
    v_mfma_f32_16x16x32_bf16 v[0:3], v[112:115], v[96:99], v[0:3]
    ds_read_b128 v[136:139], v179 offset:0
    v_mfma_f32_16x16x32_bf16 v[4:7], v[112:115], v[100:103], v[4:7]
    buffer_load_dwordx4 v194, s[12:15], s73 offen offset:1024 lds
    ds_read_b64_tr_b16 v[152:153], v185 offset:6144
    v_mfma_f32_16x16x32_bf16 v[8:11], v[112:115], v[104:107], v[8:11]
    ds_read_b64_tr_b16 v[154:155], v185 offset:6912
    v_mfma_f32_16x16x32_bf16 v[12:15], v[112:115], v[108:111], v[12:15]
    ds_read_b128 v[140:143], v179 offset:2048
    v_mfma_f32_16x16x32_bf16 v[48:51], v[124:127], v[96:99], v[48:51]
    ds_read_b64_tr_b16 v[164:165], v185 offset:18432
    v_mfma_f32_16x16x32_bf16 v[52:55], v[124:127], v[100:103], v[52:55]
    ds_read_b64_tr_b16 v[166:167], v185 offset:19200
    v_mfma_f32_16x16x32_bf16 v[56:59], v[124:127], v[104:107], v[56:59]
    buffer_load_dwordx4 v195, s[12:15], s73 offen offset:2048 lds
    ds_read_b128 v[144:147], v179 offset:4096
    v_mfma_f32_16x16x32_bf16 v[60:63], v[124:127], v[108:111], v[60:63]
    ds_read_b128 v[148:151], v179 offset:6144
    v_mfma_f32_16x16x32_bf16 v[16:19], v[116:119], v[96:99], v[16:19]
    ds_read_b64_tr_b16 v[156:157], v186 offset:6144
    v_mfma_f32_16x16x32_bf16 v[20:23], v[116:119], v[100:103], v[20:23]
    ds_read_b64_tr_b16 v[158:159], v186 offset:6912
    v_mfma_f32_16x16x32_bf16 v[24:27], v[116:119], v[104:107], v[24:27]
    ds_read_b64_tr_b16 v[160:161], v187 offset:6144
    v_mfma_f32_16x16x32_bf16 v[28:31], v[116:119], v[108:111], v[28:31]
    s_add_u32 m0, s77, 0
    s_nop 0
    buffer_load_dwordx4 v193, s[16:19], s73 offen offset:0 lds
    ds_read_b64_tr_b16 v[162:163], v187 offset:6912
    v_mfma_f32_16x16x32_bf16 v[64:67], v[128:131], v[96:99], v[64:67]
    ds_read_b64_tr_b16 v[168:169], v186 offset:18432
    v_mfma_f32_16x16x32_bf16 v[68:71], v[128:131], v[100:103], v[68:71]
    ds_read_b64_tr_b16 v[170:171], v186 offset:19200
    v_mfma_f32_16x16x32_bf16 v[72:75], v[128:131], v[104:107], v[72:75]
    ds_read_b64_tr_b16 v[172:173], v187 offset:18432
    v_mfma_f32_16x16x32_bf16 v[76:79], v[128:131], v[108:111], v[76:79]
    ds_read_b64_tr_b16 v[174:175], v187 offset:19200
    v_mfma_f32_16x16x32_bf16 v[32:35], v[120:123], v[96:99], v[32:35]
    buffer_load_dwordx4 v194, s[16:19], s73 offen offset:1024 lds
    v_mfma_f32_16x16x32_bf16 v[36:39], v[120:123], v[100:103], v[36:39]
    v_mfma_f32_16x16x32_bf16 v[40:43], v[120:123], v[104:107], v[40:43]
    v_mfma_f32_16x16x32_bf16 v[44:47], v[120:123], v[108:111], v[44:47]
    v_mfma_f32_16x16x32_bf16 v[80:83], v[132:135], v[96:99], v[80:83]
    v_mfma_f32_16x16x32_bf16 v[84:87], v[132:135], v[100:103], v[84:87]
    buffer_load_dwordx4 v195, s[16:19], s73 offen offset:2048 lds
    v_mfma_f32_16x16x32_bf16 v[88:91], v[132:135], v[104:107], v[88:91]
    v_mfma_f32_16x16x32_bf16 v[92:95], v[132:135], v[108:111], v[92:95]
    s_waitcnt vmcnt(10) lgkmcnt(0)
    s_barrier
    v_mfma_f32_16x16x32_bf16 v[0:3], v[152:155], v[136:139], v[0:3]
    ds_read_b128 v[96:99], v180 offset:0
    v_mfma_f32_16x16x32_bf16 v[4:7], v[152:155], v[140:143], v[4:7]
    s_lshl_b32 s72, s74, 7
    s_mul_i32 s73, s74, 196608
    s_add_u32 s74, s74, 1
    s_add_u32 m0, s75, 40960
    s_cmp_eq_u32 s74, 10
    s_cselect_b32 s74, 0, s74
    buffer_load_dwordx4 v191, s[8:11], s72 offen lds
    ds_read_b64_tr_b16 v[112:113], v188 offset:0
    v_mfma_f32_16x16x32_bf16 v[8:11], v[152:155], v[144:147], v[8:11]
    ds_read_b64_tr_b16 v[114:115], v188 offset:768
    v_mfma_f32_16x16x32_bf16 v[12:15], v[152:155], v[148:151], v[12:15]
    ds_read_b128 v[100:103], v180 offset:2048
    v_mfma_f32_16x16x32_bf16 v[48:51], v[164:167], v[136:139], v[48:51]
    ds_read_b64_tr_b16 v[124:125], v188 offset:12288
    v_mfma_f32_16x16x32_bf16 v[52:55], v[164:167], v[140:143], v[52:55]
    ds_read_b64_tr_b16 v[126:127], v188 offset:13056
    v_mfma_f32_16x16x32_bf16 v[56:59], v[164:167], v[144:147], v[56:59]
    s_add_u32 s70, s72, 9216
    buffer_load_dwordx4 v192, s[8:11], s70 offen offset:1024 lds
    ds_read_b128 v[104:107], v180 offset:4096
    v_mfma_f32_16x16x32_bf16 v[60:63], v[164:167], v[148:151], v[60:63]
    ds_read_b128 v[108:111], v180 offset:6144
    v_mfma_f32_16x16x32_bf16 v[16:19], v[156:159], v[136:139], v[16:19]
    ds_read_b64_tr_b16 v[116:117], v189 offset:0
    v_mfma_f32_16x16x32_bf16 v[20:23], v[156:159], v[140:143], v[20:23]
    ds_read_b64_tr_b16 v[118:119], v189 offset:768
    v_mfma_f32_16x16x32_bf16 v[24:27], v[156:159], v[144:147], v[24:27]
    ds_read_b64_tr_b16 v[120:121], v190 offset:0
    v_mfma_f32_16x16x32_bf16 v[28:31], v[156:159], v[148:151], v[28:31]
    s_add_u32 s70, s72, 18432
    buffer_load_dwordx4 v191, s[8:11], s70 offen offset:2048 lds
    ds_read_b64_tr_b16 v[122:123], v190 offset:768
    v_mfma_f32_16x16x32_bf16 v[64:67], v[168:171], v[136:139], v[64:67]
    ds_read_b64_tr_b16 v[128:129], v189 offset:12288
    v_mfma_f32_16x16x32_bf16 v[68:71], v[168:171], v[140:143], v[68:71]
    ds_read_b64_tr_b16 v[130:131], v189 offset:13056
    v_mfma_f32_16x16x32_bf16 v[72:75], v[168:171], v[144:147], v[72:75]
    ds_read_b64_tr_b16 v[132:133], v190 offset:12288
    v_mfma_f32_16x16x32_bf16 v[76:79], v[168:171], v[148:151], v[76:79]
    ds_read_b64_tr_b16 v[134:135], v190 offset:13056
    v_mfma_f32_16x16x32_bf16 v[32:35], v[160:163], v[136:139], v[32:35]
    s_add_u32 s70, s72, 27648
    buffer_load_dwordx4 v192, s[8:11], s70 offen offset:3072 lds
    v_mfma_f32_16x16x32_bf16 v[36:39], v[160:163], v[140:143], v[36:39]
    v_mfma_f32_16x16x32_bf16 v[40:43], v[160:163], v[144:147], v[40:43]
    v_mfma_f32_16x16x32_bf16 v[44:47], v[160:163], v[148:151], v[44:47]
    v_mfma_f32_16x16x32_bf16 v[80:83], v[172:175], v[136:139], v[80:83]
    v_mfma_f32_16x16x32_bf16 v[84:87], v[172:175], v[140:143], v[84:87]
    s_add_u32 m0, s76, 40960
    s_nop 0
    buffer_load_dwordx4 v193, s[12:15], s73 offen offset:0 lds
    v_mfma_f32_16x16x32_bf16 v[88:91], v[172:175], v[144:147], v[88:91]
    v_mfma_f32_16x16x32_bf16 v[92:95], v[172:175], v[148:151], v[92:95]
    s_waitcnt lgkmcnt(0)
    v_mfma_f32_16x16x32_bf16 v[0:3], v[112:115], v[96:99], v[0:3]
    ds_read_b128 v[136:139], v181 offset:0
    v_mfma_f32_16x16x32_bf16 v[4:7], v[112:115], v[100:103], v[4:7]
    buffer_load_dwordx4 v194, s[12:15], s73 offen offset:1024 lds
    ds_read_b64_tr_b16 v[152:153], v188 offset:6144
    v_mfma_f32_16x16x32_bf16 v[8:11], v[112:115], v[104:107], v[8:11]
    ds_read_b64_tr_b16 v[154:155], v188 offset:6912
    v_mfma_f32_16x16x32_bf16 v[12:15], v[112:115], v[108:111], v[12:15]
    ds_read_b128 v[140:143], v181 offset:2048
    v_mfma_f32_16x16x32_bf16 v[48:51], v[124:127], v[96:99], v[48:51]
    ds_read_b64_tr_b16 v[164:165], v188 offset:18432
    v_mfma_f32_16x16x32_bf16 v[52:55], v[124:127], v[100:103], v[52:55]
    ds_read_b64_tr_b16 v[166:167], v188 offset:19200
    v_mfma_f32_16x16x32_bf16 v[56:59], v[124:127], v[104:107], v[56:59]
    buffer_load_dwordx4 v195, s[12:15], s73 offen offset:2048 lds
    ds_read_b128 v[144:147], v181 offset:4096
    v_mfma_f32_16x16x32_bf16 v[60:63], v[124:127], v[108:111], v[60:63]
    ds_read_b128 v[148:151], v181 offset:6144
    v_mfma_f32_16x16x32_bf16 v[16:19], v[116:119], v[96:99], v[16:19]
    ds_read_b64_tr_b16 v[156:157], v189 offset:6144
    v_mfma_f32_16x16x32_bf16 v[20:23], v[116:119], v[100:103], v[20:23]
    ds_read_b64_tr_b16 v[158:159], v189 offset:6912
    v_mfma_f32_16x16x32_bf16 v[24:27], v[116:119], v[104:107], v[24:27]
    ds_read_b64_tr_b16 v[160:161], v190 offset:6144
    v_mfma_f32_16x16x32_bf16 v[28:31], v[116:119], v[108:111], v[28:31]
    s_add_u32 m0, s77, 40960
    s_nop 0
    buffer_load_dwordx4 v193, s[16:19], s73 offen offset:0 lds
    ds_read_b64_tr_b16 v[162:163], v190 offset:6912
    v_mfma_f32_16x16x32_bf16 v[64:67], v[128:131], v[96:99], v[64:67]
    ds_read_b64_tr_b16 v[168:169], v189 offset:18432
    v_mfma_f32_16x16x32_bf16 v[68:71], v[128:131], v[100:103], v[68:71]
    ds_read_b64_tr_b16 v[170:171], v189 offset:19200
    v_mfma_f32_16x16x32_bf16 v[72:75], v[128:131], v[104:107], v[72:75]
    ds_read_b64_tr_b16 v[172:173], v190 offset:18432
    v_mfma_f32_16x16x32_bf16 v[76:79], v[128:131], v[108:111], v[76:79]
    ds_read_b64_tr_b16 v[174:175], v190 offset:19200
    v_mfma_f32_16x16x32_bf16 v[32:35], v[120:123], v[96:99], v[32:35]
    buffer_load_dwordx4 v194, s[16:19], s73 offen offset:1024 lds
    v_mfma_f32_16x16x32_bf16 v[36:39], v[120:123], v[100:103], v[36:39]
    v_mfma_f32_16x16x32_bf16 v[40:43], v[120:123], v[104:107], v[40:43]
    v_mfma_f32_16x16x32_bf16 v[44:47], v[120:123], v[108:111], v[44:47]
    v_mfma_f32_16x16x32_bf16 v[80:83], v[132:135], v[96:99], v[80:83]
    v_mfma_f32_16x16x32_bf16 v[84:87], v[132:135], v[100:103], v[84:87]
    buffer_load_dwordx4 v195, s[16:19], s73 offen offset:2048 lds
    v_mfma_f32_16x16x32_bf16 v[88:91], v[132:135], v[104:107], v[88:91]
    v_mfma_f32_16x16x32_bf16 v[92:95], v[132:135], v[108:111], v[92:95]
    s_waitcnt vmcnt(10) lgkmcnt(0)
    s_barrier
    v_mfma_f32_16x16x32_bf16 v[0:3], v[152:155], v[136:139], v[0:3]
    ds_read_b128 v[96:99], v176 offset:0
    v_mfma_f32_16x16x32_bf16 v[4:7], v[152:155], v[140:143], v[4:7]
    s_lshl_b32 s72, s74, 7
    s_mul_i32 s73, s74, 196608
    s_add_u32 s74, s74, 1
    s_add_u32 m0, s75, 81920
    s_cmp_eq_u32 s74, 10
    s_cselect_b32 s74, 0, s74
    buffer_load_dwordx4 v191, s[8:11], s72 offen lds
    ds_read_b64_tr_b16 v[112:113], v182 offset:0
    v_mfma_f32_16x16x32_bf16 v[8:11], v[152:155], v[144:147], v[8:11]
    ds_read_b64_tr_b16 v[114:115], v182 offset:768
    v_mfma_f32_16x16x32_bf16 v[12:15], v[152:155], v[148:151], v[12:15]
    ds_read_b128 v[100:103], v176 offset:2048
    v_mfma_f32_16x16x32_bf16 v[48:51], v[164:167], v[136:139], v[48:51]
    ds_read_b64_tr_b16 v[124:125], v182 offset:12288
    v_mfma_f32_16x16x32_bf16 v[52:55], v[164:167], v[140:143], v[52:55]
    ds_read_b64_tr_b16 v[126:127], v182 offset:13056
    v_mfma_f32_16x16x32_bf16 v[56:59], v[164:167], v[144:147], v[56:59]
    s_add_u32 s70, s72, 9216
    buffer_load_dwordx4 v192, s[8:11], s70 offen offset:1024 lds
    ds_read_b128 v[104:107], v176 offset:4096
    v_mfma_f32_16x16x32_bf16 v[60:63], v[164:167], v[148:151], v[60:63]
    ds_read_b128 v[108:111], v176 offset:6144
    v_mfma_f32_16x16x32_bf16 v[16:19], v[156:159], v[136:139], v[16:19]
    ds_read_b64_tr_b16 v[116:117], v183 offset:0
    v_mfma_f32_16x16x32_bf16 v[20:23], v[156:159], v[140:143], v[20:23]
    ds_read_b64_tr_b16 v[118:119], v183 offset:768
    v_mfma_f32_16x16x32_bf16 v[24:27], v[156:159], v[144:147], v[24:27]
    ds_read_b64_tr_b16 v[120:121], v184 offset:0
    v_mfma_f32_16x16x32_bf16 v[28:31], v[156:159], v[148:151], v[28:31]
    s_add_u32 s70, s72, 18432
    buffer_load_dwordx4 v191, s[8:11], s70 offen offset:2048 lds
    ds_read_b64_tr_b16 v[122:123], v184 offset:768
    v_mfma_f32_16x16x32_bf16 v[64:67], v[168:171], v[136:139], v[64:67]
    ds_read_b64_tr_b16 v[128:129], v183 offset:12288
    v_mfma_f32_16x16x32_bf16 v[68:71], v[168:171], v[140:143], v[68:71]
    ds_read_b64_tr_b16 v[130:131], v183 offset:13056
    v_mfma_f32_16x16x32_bf16 v[72:75], v[168:171], v[144:147], v[72:75]
    ds_read_b64_tr_b16 v[132:133], v184 offset:12288
    v_mfma_f32_16x16x32_bf16 v[76:79], v[168:171], v[148:151], v[76:79]
    ds_read_b64_tr_b16 v[134:135], v184 offset:13056
    v_mfma_f32_16x16x32_bf16 v[32:35], v[160:163], v[136:139], v[32:35]
    s_add_u32 s70, s72, 27648
    buffer_load_dwordx4 v192, s[8:11], s70 offen offset:3072 lds
    v_mfma_f32_16x16x32_bf16 v[36:39], v[160:163], v[140:143], v[36:39]
    v_mfma_f32_16x16x32_bf16 v[40:43], v[160:163], v[144:147], v[40:43]
    v_mfma_f32_16x16x32_bf16 v[44:47], v[160:163], v[148:151], v[44:47]
    v_mfma_f32_16x16x32_bf16 v[80:83], v[172:175], v[136:139], v[80:83]
    v_mfma_f32_16x16x32_bf16 v[84:87], v[172:175], v[140:143], v[84:87]
    s_add_u32 m0, s76, 81920
    s_nop 0
    buffer_load_dwordx4 v193, s[12:15], s73 offen offset:0 lds
    v_mfma_f32_16x16x32_bf16 v[88:91], v[172:175], v[144:147], v[88:91]
    v_mfma_f32_16x16x32_bf16 v[92:95], v[172:175], v[148:151], v[92:95]
    s_waitcnt lgkmcnt(0)
    v_mfma_f32_16x16x32_bf16 v[0:3], v[112:115], v[96:99], v[0:3]
    ds_read_b128 v[136:139], v177 offset:0
    v_mfma_f32_16x16x32_bf16 v[4:7], v[112:115], v[100:103], v[4:7]
    buffer_load_dwordx4 v194, s[12:15], s73 offen offset:1024 lds
    ds_read_b64_tr_b16 v[152:153], v182 offset:6144
    v_mfma_f32_16x16x32_bf16 v[8:11], v[112:115], v[104:107], v[8:11]
    ds_read_b64_tr_b16 v[154:155], v182 offset:6912
    v_mfma_f32_16x16x32_bf16 v[12:15], v[112:115], v[108:111], v[12:15]
    ds_read_b128 v[140:143], v177 offset:2048
    v_mfma_f32_16x16x32_bf16 v[48:51], v[124:127], v[96:99], v[48:51]
    ds_read_b64_tr_b16 v[164:165], v182 offset:18432
    v_mfma_f32_16x16x32_bf16 v[52:55], v[124:127], v[100:103], v[52:55]
    ds_read_b64_tr_b16 v[166:167], v182 offset:19200
    v_mfma_f32_16x16x32_bf16 v[56:59], v[124:127], v[104:107], v[56:59]
    buffer_load_dwordx4 v195, s[12:15], s73 offen offset:2048 lds
    ds_read_b128 v[144:147], v177 offset:4096
    v_mfma_f32_16x16x32_bf16 v[60:63], v[124:127], v[108:111], v[60:63]
    ds_read_b128 v[148:151], v177 offset:6144
    v_mfma_f32_16x16x32_bf16 v[16:19], v[116:119], v[96:99], v[16:19]
    ds_read_b64_tr_b16 v[156:157], v183 offset:6144
    v_mfma_f32_16x16x32_bf16 v[20:23], v[116:119], v[100:103], v[20:23]
    ds_read_b64_tr_b16 v[158:159], v183 offset:6912
    v_mfma_f32_16x16x32_bf16 v[24:27], v[116:119], v[104:107], v[24:27]
    ds_read_b64_tr_b16 v[160:161], v184 offset:6144
    v_mfma_f32_16x16x32_bf16 v[28:31], v[116:119], v[108:111], v[28:31]
    s_add_u32 m0, s77, 81920
    s_nop 0
    buffer_load_dwordx4 v193, s[16:19], s73 offen offset:0 lds
    ds_read_b64_tr_b16 v[162:163], v184 offset:6912
    v_mfma_f32_16x16x32_bf16 v[64:67], v[128:131], v[96:99], v[64:67]
    ds_read_b64_tr_b16 v[168:169], v183 offset:18432
    v_mfma_f32_16x16x32_bf16 v[68:71], v[128:131], v[100:103], v[68:71]
    ds_read_b64_tr_b16 v[170:171], v183 offset:19200
    v_mfma_f32_16x16x32_bf16 v[72:75], v[128:131], v[104:107], v[72:75]
    ds_read_b64_tr_b16 v[172:173], v184 offset:18432
    v_mfma_f32_16x16x32_bf16 v[76:79], v[128:131], v[108:111], v[76:79]
    ds_read_b64_tr_b16 v[174:175], v184 offset:19200
    v_mfma_f32_16x16x32_bf16 v[32:35], v[120:123], v[96:99], v[32:35]
    buffer_load_dwordx4 v194, s[16:19], s73 offen offset:1024 lds
    v_mfma_f32_16x16x32_bf16 v[36:39], v[120:123], v[100:103], v[36:39]
    v_mfma_f32_16x16x32_bf16 v[40:43], v[120:123], v[104:107], v[40:43]
    v_mfma_f32_16x16x32_bf16 v[44:47], v[120:123], v[108:111], v[44:47]
    v_mfma_f32_16x16x32_bf16 v[80:83], v[132:135], v[96:99], v[80:83]
    v_mfma_f32_16x16x32_bf16 v[84:87], v[132:135], v[100:103], v[84:87]
    buffer_load_dwordx4 v195, s[16:19], s73 offen offset:2048 lds
    v_mfma_f32_16x16x32_bf16 v[88:91], v[132:135], v[104:107], v[88:91]
    v_mfma_f32_16x16x32_bf16 v[92:95], v[132:135], v[108:111], v[92:95]
    s_waitcnt vmcnt(10) lgkmcnt(0)
    s_barrier
    v_mfma_f32_16x16x32_bf16 v[0:3], v[152:155], v[136:139], v[0:3]
    ds_read_b128 v[96:99], v178 offset:0
    v_mfma_f32_16x16x32_bf16 v[4:7], v[152:155], v[140:143], v[4:7]
    s_lshl_b32 s72, s74, 7
    s_mul_i32 s73, s74, 196608
    s_add_u32 s74, s74, 1
    s_add_u32 m0, s75, 0
    s_cmp_eq_u32 s74, 10
    s_cselect_b32 s74, 0, s74
    buffer_load_dwordx4 v191, s[8:11], s72 offen lds
    ds_read_b64_tr_b16 v[112:113], v185 offset:0
    v_mfma_f32_16x16x32_bf16 v[8:11], v[152:155], v[144:147], v[8:11]
    ds_read_b64_tr_b16 v[114:115], v185 offset:768
    v_mfma_f32_16x16x32_bf16 v[12:15], v[152:155], v[148:151], v[12:15]
    ds_read_b128 v[100:103], v178 offset:2048
    v_mfma_f32_16x16x32_bf16 v[48:51], v[164:167], v[136:139], v[48:51]
    ds_read_b64_tr_b16 v[124:125], v185 offset:12288
    v_mfma_f32_16x16x32_bf16 v[52:55], v[164:167], v[140:143], v[52:55]
    ds_read_b64_tr_b16 v[126:127], v185 offset:13056
    v_mfma_f32_16x16x32_bf16 v[56:59], v[164:167], v[144:147], v[56:59]
    s_add_u32 s70, s72, 9216
    buffer_load_dwordx4 v192, s[8:11], s70 offen offset:1024 lds
    ds_read_b128 v[104:107], v178 offset:4096
    v_mfma_f32_16x16x32_bf16 v[60:63], v[164:167], v[148:151], v[60:63]
    ds_read_b128 v[108:111], v178 offset:6144
    v_mfma_f32_16x16x32_bf16 v[16:19], v[156:159], v[136:139], v[16:19]
    ds_read_b64_tr_b16 v[116:117], v186 offset:0
    v_mfma_f32_16x16x32_bf16 v[20:23], v[156:159], v[140:143], v[20:23]
    ds_read_b64_tr_b16 v[118:119], v186 offset:768
    v_mfma_f32_16x16x32_bf16 v[24:27], v[156:159], v[144:147], v[24:27]
    ds_read_b64_tr_b16 v[120:121], v187 offset:0
    v_mfma_f32_16x16x32_bf16 v[28:31], v[156:159], v[148:151], v[28:31]
    s_add_u32 s70, s72, 18432
    buffer_load_dwordx4 v191, s[8:11], s70 offen offset:2048 lds
    ds_read_b64_tr_b16 v[122:123], v187 offset:768
    v_mfma_f32_16x16x32_bf16 v[64:67], v[168:171], v[136:139], v[64:67]
    ds_read_b64_tr_b16 v[128:129], v186 offset:12288
    v_mfma_f32_16x16x32_bf16 v[68:71], v[168:171], v[140:143], v[68:71]
    ds_read_b64_tr_b16 v[130:131], v186 offset:13056
    v_mfma_f32_16x16x32_bf16 v[72:75], v[168:171], v[144:147], v[72:75]
    ds_read_b64_tr_b16 v[132:133], v187 offset:12288
    v_mfma_f32_16x16x32_bf16 v[76:79], v[168:171], v[148:151], v[76:79]
    ds_read_b64_tr_b16 v[134:135], v187 offset:13056
    v_mfma_f32_16x16x32_bf16 v[32:35], v[160:163], v[136:139], v[32:35]
    s_add_u32 s70, s72, 27648
    buffer_load_dwordx4 v192, s[8:11], s70 offen offset:3072 lds
    v_mfma_f32_16x16x32_bf16 v[36:39], v[160:163], v[140:143], v[36:39]
    v_mfma_f32_16x16x32_bf16 v[40:43], v[160:163], v[144:147], v[40:43]
    v_mfma_f32_16x16x32_bf16 v[44:47], v[160:163], v[148:151], v[44:47]
    v_mfma_f32_16x16x32_bf16 v[80:83], v[172:175], v[136:139], v[80:83]
    v_mfma_f32_16x16x32_bf16 v[84:87], v[172:175], v[140:143], v[84:87]
    s_add_u32 m0, s76, 0
    s_nop 0
    buffer_load_dwordx4 v193, s[12:15], s73 offen offset:0 lds
    v_mfma_f32_16x16x32_bf16 v[88:91], v[172:175], v[144:147], v[88:91]
    v_mfma_f32_16x16x32_bf16 v[92:95], v[172:175], v[148:151], v[92:95]
    s_waitcnt lgkmcnt(0)
    v_mfma_f32_16x16x32_bf16 v[0:3], v[112:115], v[96:99], v[0:3]
    ds_read_b128 v[136:139], v179 offset:0
    v_mfma_f32_16x16x32_bf16 v[4:7], v[112:115], v[100:103], v[4:7]
    buffer_load_dwordx4 v194, s[12:15], s73 offen offset:1024 lds
    ds_read_b64_tr_b16 v[152:153], v185 offset:6144
    v_mfma_f32_16x16x32_bf16 v[8:11], v[112:115], v[104:107], v[8:11]
    ds_read_b64_tr_b16 v[154:155], v185 offset:6912
    v_mfma_f32_16x16x32_bf16 v[12:15], v[112:115], v[108:111], v[12:15]
    ds_read_b128 v[140:143], v179 offset:2048
    v_mfma_f32_16x16x32_bf16 v[48:51], v[124:127], v[96:99], v[48:51]
    ds_read_b64_tr_b16 v[164:165], v185 offset:18432
    v_mfma_f32_16x16x32_bf16 v[52:55], v[124:127], v[100:103], v[52:55]
    ds_read_b64_tr_b16 v[166:167], v185 offset:19200
    v_mfma_f32_16x16x32_bf16 v[56:59], v[124:127], v[104:107], v[56:59]
    buffer_load_dwordx4 v195, s[12:15], s73 offen offset:2048 lds
    ds_read_b128 v[144:147], v179 offset:4096
    v_mfma_f32_16x16x32_bf16 v[60:63], v[124:127], v[108:111], v[60:63]
    ds_read_b128 v[148:151], v179 offset:6144
    v_mfma_f32_16x16x32_bf16 v[16:19], v[116:119], v[96:99], v[16:19]
    ds_read_b64_tr_b16 v[156:157], v186 offset:6144
    v_mfma_f32_16x16x32_bf16 v[20:23], v[116:119], v[100:103], v[20:23]
    ds_read_b64_tr_b16 v[158:159], v186 offset:6912
    v_mfma_f32_16x16x32_bf16 v[24:27], v[116:119], v[104:107], v[24:27]
    ds_read_b64_tr_b16 v[160:161], v187 offset:6144
    v_mfma_f32_16x16x32_bf16 v[28:31], v[116:119], v[108:111], v[28:31]
    s_add_u32 m0, s77, 0
    s_nop 0
    buffer_load_dwordx4 v193, s[16:19], s73 offen offset:0 lds
    ds_read_b64_tr_b16 v[162:163], v187 offset:6912
    v_mfma_f32_16x16x32_bf16 v[64:67], v[128:131], v[96:99], v[64:67]
    ds_read_b64_tr_b16 v[168:169], v186 offset:18432
    v_mfma_f32_16x16x32_bf16 v[68:71], v[128:131], v[100:103], v[68:71]
    ds_read_b64_tr_b16 v[170:171], v186 offset:19200
    v_mfma_f32_16x16x32_bf16 v[72:75], v[128:131], v[104:107], v[72:75]
    ds_read_b64_tr_b16 v[172:173], v187 offset:18432
    v_mfma_f32_16x16x32_bf16 v[76:79], v[128:131], v[108:111], v[76:79]
    ds_read_b64_tr_b16 v[174:175], v187 offset:19200
    v_mfma_f32_16x16x32_bf16 v[32:35], v[120:123], v[96:99], v[32:35]
    buffer_load_dwordx4 v194, s[16:19], s73 offen offset:1024 lds
    v_mfma_f32_16x16x32_bf16 v[36:39], v[120:123], v[100:103], v[36:39]
    v_mfma_f32_16x16x32_bf16 v[40:43], v[120:123], v[104:107], v[40:43]
    v_mfma_f32_16x16x32_bf16 v[44:47], v[120:123], v[108:111], v[44:47]
    v_mfma_f32_16x16x32_bf16 v[80:83], v[132:135], v[96:99], v[80:83]
    v_mfma_f32_16x16x32_bf16 v[84:87], v[132:135], v[100:103], v[84:87]
    buffer_load_dwordx4 v195, s[16:19], s73 offen offset:2048 lds
    v_mfma_f32_16x16x32_bf16 v[88:91], v[132:135], v[104:107], v[88:91]
    v_mfma_f32_16x16x32_bf16 v[92:95], v[132:135], v[108:111], v[92:95]
    s_waitcnt vmcnt(10) lgkmcnt(0)
    s_barrier
    v_mfma_f32_16x16x32_bf16 v[0:3], v[152:155], v[136:139], v[0:3]
    ds_read_b128 v[96:99], v180 offset:0
    v_mfma_f32_16x16x32_bf16 v[4:7], v[152:155], v[140:143], v[4:7]
    s_lshl_b32 s72, s74, 7
    s_mul_i32 s73, s74, 196608
    s_add_u32 s74, s74, 1
    s_add_u32 m0, s75, 40960
    s_cmp_eq_u32 s74, 10
    s_cselect_b32 s74, 0, s74
    buffer_load_dwordx4 v191, s[8:11], s72 offen lds
    ds_read_b64_tr_b16 v[112:113], v188 offset:0
    v_mfma_f32_16x16x32_bf16 v[8:11], v[152:155], v[144:147], v[8:11]
    ds_read_b64_tr_b16 v[114:115], v188 offset:768
    v_mfma_f32_16x16x32_bf16 v[12:15], v[152:155], v[148:151], v[12:15]
    ds_read_b128 v[100:103], v180 offset:2048
    v_mfma_f32_16x16x32_bf16 v[48:51], v[164:167], v[136:139], v[48:51]
    ds_read_b64_tr_b16 v[124:125], v188 offset:12288
    v_mfma_f32_16x16x32_bf16 v[52:55], v[164:167], v[140:143], v[52:55]
    ds_read_b64_tr_b16 v[126:127], v188 offset:13056
    v_mfma_f32_16x16x32_bf16 v[56:59], v[164:167], v[144:147], v[56:59]
    s_add_u32 s70, s72, 9216
    buffer_load_dwordx4 v192, s[8:11], s70 offen offset:1024 lds
    ds_read_b128 v[104:107], v180 offset:4096
    v_mfma_f32_16x16x32_bf16 v[60:63], v[164:167], v[148:151], v[60:63]
    ds_read_b128 v[108:111], v180 offset:6144
    v_mfma_f32_16x16x32_bf16 v[16:19], v[156:159], v[136:139], v[16:19]
    ds_read_b64_tr_b16 v[116:117], v189 offset:0
    v_mfma_f32_16x16x32_bf16 v[20:23], v[156:159], v[140:143], v[20:23]
    ds_read_b64_tr_b16 v[118:119], v189 offset:768
    v_mfma_f32_16x16x32_bf16 v[24:27], v[156:159], v[144:147], v[24:27]
    ds_read_b64_tr_b16 v[120:121], v190 offset:0
    v_mfma_f32_16x16x32_bf16 v[28:31], v[156:159], v[148:151], v[28:31]
    s_add_u32 s70, s72, 18432
    buffer_load_dwordx4 v191, s[8:11], s70 offen offset:2048 lds
    ds_read_b64_tr_b16 v[122:123], v190 offset:768
    v_mfma_f32_16x16x32_bf16 v[64:67], v[168:171], v[136:139], v[64:67]
    ds_read_b64_tr_b16 v[128:129], v189 offset:12288
    v_mfma_f32_16x16x32_bf16 v[68:71], v[168:171], v[140:143], v[68:71]
    ds_read_b64_tr_b16 v[130:131], v189 offset:13056
    v_mfma_f32_16x16x32_bf16 v[72:75], v[168:171], v[144:147], v[72:75]
    ds_read_b64_tr_b16 v[132:133], v190 offset:12288
    v_mfma_f32_16x16x32_bf16 v[76:79], v[168:171], v[148:151], v[76:79]
    ds_read_b64_tr_b16 v[134:135], v190 offset:13056
    v_mfma_f32_16x16x32_bf16 v[32:35], v[160:163], v[136:139], v[32:35]
    s_add_u32 s70, s72, 27648
    buffer_load_dwordx4 v192, s[8:11], s70 offen offset:3072 lds
    v_mfma_f32_16x16x32_bf16 v[36:39], v[160:163], v[140:143], v[36:39]
    v_mfma_f32_16x16x32_bf16 v[40:43], v[160:163], v[144:147], v[40:43]
    v_mfma_f32_16x16x32_bf16 v[44:47], v[160:163], v[148:151], v[44:47]
    v_mfma_f32_16x16x32_bf16 v[80:83], v[172:175], v[136:139], v[80:83]
    v_mfma_f32_16x16x32_bf16 v[84:87], v[172:175], v[140:143], v[84:87]
    s_add_u32 m0, s76, 40960
    s_nop 0
    buffer_load_dwordx4 v193, s[12:15], s73 offen offset:0 lds
    v_mfma_f32_16x16x32_bf16 v[88:91], v[172:175], v[144:147], v[88:91]
    v_mfma_f32_16x16x32_bf16 v[92:95], v[172:175], v[148:151], v[92:95]
    s_waitcnt lgkmcnt(0)
    v_mfma_f32_16x16x32_bf16 v[0:3], v[112:115], v[96:99], v[0:3]
    ds_read_b128 v[136:139], v181 offset:0
    v_mfma_f32_16x16x32_bf16 v[4:7], v[112:115], v[100:103], v[4:7]
    buffer_load_dwordx4 v194, s[12:15], s73 offen offset:1024 lds
    ds_read_b64_tr_b16 v[152:153], v188 offset:6144
    v_mfma_f32_16x16x32_bf16 v[8:11], v[112:115], v[104:107], v[8:11]
    ds_read_b64_tr_b16 v[154:155], v188 offset:6912
    v_mfma_f32_16x16x32_bf16 v[12:15], v[112:115], v[108:111], v[12:15]
    ds_read_b128 v[140:143], v181 offset:2048
    v_mfma_f32_16x16x32_bf16 v[48:51], v[124:127], v[96:99], v[48:51]
    ds_read_b64_tr_b16 v[164:165], v188 offset:18432
    v_mfma_f32_16x16x32_bf16 v[52:55], v[124:127], v[100:103], v[52:55]
    ds_read_b64_tr_b16 v[166:167], v188 offset:19200
    v_mfma_f32_16x16x32_bf16 v[56:59], v[124:127], v[104:107], v[56:59]
    buffer_load_dwordx4 v195, s[12:15], s73 offen offset:2048 lds
    ds_read_b128 v[144:147], v181 offset:4096
    v_mfma_f32_16x16x32_bf16 v[60:63], v[124:127], v[108:111], v[60:63]
    ds_read_b128 v[148:151], v181 offset:6144
    v_mfma_f32_16x16x32_bf16 v[16:19], v[116:119], v[96:99], v[16:19]
    ds_read_b64_tr_b16 v[156:157], v189 offset:6144
    v_mfma_f32_16x16x32_bf16 v[20:23], v[116:119], v[100:103], v[20:23]
    ds_read_b64_tr_b16 v[158:159], v189 offset:6912
    v_mfma_f32_16x16x32_bf16 v[24:27], v[116:119], v[104:107], v[24:27]
    ds_read_b64_tr_b16 v[160:161], v190 offset:6144
    v_mfma_f32_16x16x32_bf16 v[28:31], v[116:119], v[108:111], v[28:31]
    s_add_u32 m0, s77, 40960
    s_nop 0
    buffer_load_dwordx4 v193, s[16:19], s73 offen offset:0 lds
    ds_read_b64_tr_b16 v[162:163], v190 offset:6912
    v_mfma_f32_16x16x32_bf16 v[64:67], v[128:131], v[96:99], v[64:67]
    ds_read_b64_tr_b16 v[168:169], v189 offset:18432
    v_mfma_f32_16x16x32_bf16 v[68:71], v[128:131], v[100:103], v[68:71]
    ds_read_b64_tr_b16 v[170:171], v189 offset:19200
    v_mfma_f32_16x16x32_bf16 v[72:75], v[128:131], v[104:107], v[72:75]
    ds_read_b64_tr_b16 v[172:173], v190 offset:18432
    v_mfma_f32_16x16x32_bf16 v[76:79], v[128:131], v[108:111], v[76:79]
    ds_read_b64_tr_b16 v[174:175], v190 offset:19200
    v_mfma_f32_16x16x32_bf16 v[32:35], v[120:123], v[96:99], v[32:35]
    buffer_load_dwordx4 v194, s[16:19], s73 offen offset:1024 lds
    v_mfma_f32_16x16x32_bf16 v[36:39], v[120:123], v[100:103], v[36:39]
    v_mfma_f32_16x16x32_bf16 v[40:43], v[120:123], v[104:107], v[40:43]
    v_mfma_f32_16x16x32_bf16 v[44:47], v[120:123], v[108:111], v[44:47]
    v_mfma_f32_16x16x32_bf16 v[80:83], v[132:135], v[96:99], v[80:83]
    v_mfma_f32_16x16x32_bf16 v[84:87], v[132:135], v[100:103], v[84:87]
    buffer_load_dwordx4 v195, s[16:19], s73 offen offset:2048 lds
    v_mfma_f32_16x16x32_bf16 v[88:91], v[132:135], v[104:107], v[88:91]
    v_mfma_f32_16x16x32_bf16 v[92:95], v[132:135], v[108:111], v[92:95]
    s_waitcnt vmcnt(10) lgkmcnt(0)
    s_barrier
    v_mfma_f32_16x16x32_bf16 v[0:3], v[152:155], v[136:139], v[0:3]
    ds_read_b128 v[96:99], v176 offset:0
    v_mfma_f32_16x16x32_bf16 v[4:7], v[152:155], v[140:143], v[4:7]
    s_lshl_b32 s72, s74, 7
    s_mul_i32 s73, s74, 196608
    s_add_u32 s74, s74, 1
    s_add_u32 m0, s75, 81920
    s_cmp_eq_u32 s74, 10
    s_cselect_b32 s74, 0, s74
    buffer_load_dwordx4 v191, s[8:11], s72 offen lds
    ds_read_b64_tr_b16 v[112:113], v182 offset:0
    v_mfma_f32_16x16x32_bf16 v[8:11], v[152:155], v[144:147], v[8:11]
    ds_read_b64_tr_b16 v[114:115], v182 offset:768
    v_mfma_f32_16x16x32_bf16 v[12:15], v[152:155], v[148:151], v[12:15]
    ds_read_b128 v[100:103], v176 offset:2048
    v_mfma_f32_16x16x32_bf16 v[48:51], v[164:167], v[136:139], v[48:51]
    ds_read_b64_tr_b16 v[124:125], v182 offset:12288
    v_mfma_f32_16x16x32_bf16 v[52:55], v[164:167], v[140:143], v[52:55]
    ds_read_b64_tr_b16 v[126:127], v182 offset:13056
    v_mfma_f32_16x16x32_bf16 v[56:59], v[164:167], v[144:147], v[56:59]
    s_add_u32 s70, s72, 9216
    buffer_load_dwordx4 v192, s[8:11], s70 offen offset:1024 lds
    ds_read_b128 v[104:107], v176 offset:4096
    v_mfma_f32_16x16x32_bf16 v[60:63], v[164:167], v[148:151], v[60:63]
    ds_read_b128 v[108:111], v176 offset:6144
    v_mfma_f32_16x16x32_bf16 v[16:19], v[156:159], v[136:139], v[16:19]
    ds_read_b64_tr_b16 v[116:117], v183 offset:0
    v_mfma_f32_16x16x32_bf16 v[20:23], v[156:159], v[140:143], v[20:23]
    ds_read_b64_tr_b16 v[118:119], v183 offset:768
    v_mfma_f32_16x16x32_bf16 v[24:27], v[156:159], v[144:147], v[24:27]
    ds_read_b64_tr_b16 v[120:121], v184 offset:0
    v_mfma_f32_16x16x32_bf16 v[28:31], v[156:159], v[148:151], v[28:31]
    s_add_u32 s70, s72, 18432
    buffer_load_dwordx4 v191, s[8:11], s70 offen offset:2048 lds
    ds_read_b64_tr_b16 v[122:123], v184 offset:768
    v_mfma_f32_16x16x32_bf16 v[64:67], v[168:171], v[136:139], v[64:67]
    ds_read_b64_tr_b16 v[128:129], v183 offset:12288
    v_mfma_f32_16x16x32_bf16 v[68:71], v[168:171], v[140:143], v[68:71]
    ds_read_b64_tr_b16 v[130:131], v183 offset:13056
    v_mfma_f32_16x16x32_bf16 v[72:75], v[168:171], v[144:147], v[72:75]
    ds_read_b64_tr_b16 v[132:133], v184 offset:12288
    v_mfma_f32_16x16x32_bf16 v[76:79], v[168:171], v[148:151], v[76:79]
    ds_read_b64_tr_b16 v[134:135], v184 offset:13056
    v_mfma_f32_16x16x32_bf16 v[32:35], v[160:163], v[136:139], v[32:35]
    s_add_u32 s70, s72, 27648
    buffer_load_dwordx4 v192, s[8:11], s70 offen offset:3072 lds
    v_mfma_f32_16x16x32_bf16 v[36:39], v[160:163], v[140:143], v[36:39]
    v_mfma_f32_16x16x32_bf16 v[40:43], v[160:163], v[144:147], v[40:43]
    v_mfma_f32_16x16x32_bf16 v[44:47], v[160:163], v[148:151], v[44:47]
    v_mfma_f32_16x16x32_bf16 v[80:83], v[172:175], v[136:139], v[80:83]
    v_mfma_f32_16x16x32_bf16 v[84:87], v[172:175], v[140:143], v[84:87]
    s_add_u32 m0, s76, 81920
    s_nop 0
    buffer_load_dwordx4 v193, s[12:15], s73 offen offset:0 lds
    v_mfma_f32_16x16x32_bf16 v[88:91], v[172:175], v[144:147], v[88:91]
    v_mfma_f32_16x16x32_bf16 v[92:95], v[172:175], v[148:151], v[92:95]
    s_waitcnt lgkmcnt(0)
    v_mfma_f32_16x16x32_bf16 v[0:3], v[112:115], v[96:99], v[0:3]
    ds_read_b128 v[136:139], v177 offset:0
    v_mfma_f32_16x16x32_bf16 v[4:7], v[112:115], v[100:103], v[4:7]
    buffer_load_dwordx4 v194, s[12:15], s73 offen offset:1024 lds
    ds_read_b64_tr_b16 v[152:153], v182 offset:6144
    v_mfma_f32_16x16x32_bf16 v[8:11], v[112:115], v[104:107], v[8:11]
    ds_read_b64_tr_b16 v[154:155], v182 offset:6912
    v_mfma_f32_16x16x32_bf16 v[12:15], v[112:115], v[108:111], v[12:15]
    ds_read_b128 v[140:143], v177 offset:2048
    v_mfma_f32_16x16x32_bf16 v[48:51], v[124:127], v[96:99], v[48:51]
    ds_read_b64_tr_b16 v[164:165], v182 offset:18432
    v_mfma_f32_16x16x32_bf16 v[52:55], v[124:127], v[100:103], v[52:55]
    ds_read_b64_tr_b16 v[166:167], v182 offset:19200
    v_mfma_f32_16x16x32_bf16 v[56:59], v[124:127], v[104:107], v[56:59]
    buffer_load_dwordx4 v195, s[12:15], s73 offen offset:2048 lds
    ds_read_b128 v[144:147], v177 offset:4096
    v_mfma_f32_16x16x32_bf16 v[60:63], v[124:127], v[108:111], v[60:63]
    ds_read_b128 v[148:151], v177 offset:6144
    v_mfma_f32_16x16x32_bf16 v[16:19], v[116:119], v[96:99], v[16:19]
    ds_read_b64_tr_b16 v[156:157], v183 offset:6144
    v_mfma_f32_16x16x32_bf16 v[20:23], v[116:119], v[100:103], v[20:23]
    ds_read_b64_tr_b16 v[158:159], v183 offset:6912
    v_mfma_f32_16x16x32_bf16 v[24:27], v[116:119], v[104:107], v[24:27]
    ds_read_b64_tr_b16 v[160:161], v184 offset:6144
    v_mfma_f32_16x16x32_bf16 v[28:31], v[116:119], v[108:111], v[28:31]
    s_add_u32 m0, s77, 81920
    s_nop 0
    buffer_load_dwordx4 v193, s[16:19], s73 offen offset:0 lds
    ds_read_b64_tr_b16 v[162:163], v184 offset:6912
    v_mfma_f32_16x16x32_bf16 v[64:67], v[128:131], v[96:99], v[64:67]
    ds_read_b64_tr_b16 v[168:169], v183 offset:18432
    v_mfma_f32_16x16x32_bf16 v[68:71], v[128:131], v[100:103], v[68:71]
    ds_read_b64_tr_b16 v[170:171], v183 offset:19200
    v_mfma_f32_16x16x32_bf16 v[72:75], v[128:131], v[104:107], v[72:75]
    ds_read_b64_tr_b16 v[172:173], v184 offset:18432
    v_mfma_f32_16x16x32_bf16 v[76:79], v[128:131], v[108:111], v[76:79]
    ds_read_b64_tr_b16 v[174:175], v184 offset:19200
    v_mfma_f32_16x16x32_bf16 v[32:35], v[120:123], v[96:99], v[32:35]
    buffer_load_dwordx4 v194, s[16:19], s73 offen offset:1024 lds
    v_mfma_f32_16x16x32_bf16 v[36:39], v[120:123], v[100:103], v[36:39]
    v_mfma_f32_16x16x32_bf16 v[40:43], v[120:123], v[104:107], v[40:43]
    v_mfma_f32_16x16x32_bf16 v[44:47], v[120:123], v[108:111], v[44:47]
    v_mfma_f32_16x16x32_bf16 v[80:83], v[132:135], v[96:99], v[80:83]
    v_mfma_f32_16x16x32_bf16 v[84:87], v[132:135], v[100:103], v[84:87]
    buffer_load_dwordx4 v195, s[16:19], s73 offen offset:2048 lds
    v_mfma_f32_16x16x32_bf16 v[88:91], v[132:135], v[104:107], v[88:91]
    v_mfma_f32_16x16x32_bf16 v[92:95], v[132:135], v[108:111], v[92:95]
    s_waitcnt vmcnt(10) lgkmcnt(0)
    s_barrier
    v_mfma_f32_16x16x32_bf16 v[0:3], v[152:155], v[136:139], v[0:3]
    ds_read_b128 v[96:99], v178 offset:0
    v_mfma_f32_16x16x32_bf16 v[4:7], v[152:155], v[140:143], v[4:7]
    s_lshl_b32 s72, s74, 7
    s_mul_i32 s73, s74, 196608
    s_add_u32 s74, s74, 1
    s_add_u32 m0, s75, 0
    s_cmp_eq_u32 s74, 10
    s_cselect_b32 s74, 0, s74
    buffer_load_dwordx4 v191, s[8:11], s72 offen lds
    ds_read_b64_tr_b16 v[112:113], v185 offset:0
    v_mfma_f32_16x16x32_bf16 v[8:11], v[152:155], v[144:147], v[8:11]
    ds_read_b64_tr_b16 v[114:115], v185 offset:768
    v_mfma_f32_16x16x32_bf16 v[12:15], v[152:155], v[148:151], v[12:15]
    ds_read_b128 v[100:103], v178 offset:2048
    v_mfma_f32_16x16x32_bf16 v[48:51], v[164:167], v[136:139], v[48:51]
    ds_read_b64_tr_b16 v[124:125], v185 offset:12288
    v_mfma_f32_16x16x32_bf16 v[52:55], v[164:167], v[140:143], v[52:55]
    ds_read_b64_tr_b16 v[126:127], v185 offset:13056
    v_mfma_f32_16x16x32_bf16 v[56:59], v[164:167], v[144:147], v[56:59]
    s_add_u32 s70, s72, 9216
    buffer_load_dwordx4 v192, s[8:11], s70 offen offset:1024 lds
    ds_read_b128 v[104:107], v178 offset:4096
    v_mfma_f32_16x16x32_bf16 v[60:63], v[164:167], v[148:151], v[60:63]
    ds_read_b128 v[108:111], v178 offset:6144
    v_mfma_f32_16x16x32_bf16 v[16:19], v[156:159], v[136:139], v[16:19]
    ds_read_b64_tr_b16 v[116:117], v186 offset:0
    v_mfma_f32_16x16x32_bf16 v[20:23], v[156:159], v[140:143], v[20:23]
    ds_read_b64_tr_b16 v[118:119], v186 offset:768
    v_mfma_f32_16x16x32_bf16 v[24:27], v[156:159], v[144:147], v[24:27]
    ds_read_b64_tr_b16 v[120:121], v187 offset:0
    v_mfma_f32_16x16x32_bf16 v[28:31], v[156:159], v[148:151], v[28:31]
    s_add_u32 s70, s72, 18432
    buffer_load_dwordx4 v191, s[8:11], s70 offen offset:2048 lds
    ds_read_b64_tr_b16 v[122:123], v187 offset:768
    v_mfma_f32_16x16x32_bf16 v[64:67], v[168:171], v[136:139], v[64:67]
    ds_read_b64_tr_b16 v[128:129], v186 offset:12288
    v_mfma_f32_16x16x32_bf16 v[68:71], v[168:171], v[140:143], v[68:71]
    ds_read_b64_tr_b16 v[130:131], v186 offset:13056
    v_mfma_f32_16x16x32_bf16 v[72:75], v[168:171], v[144:147], v[72:75]
    ds_read_b64_tr_b16 v[132:133], v187 offset:12288
    v_mfma_f32_16x16x32_bf16 v[76:79], v[168:171], v[148:151], v[76:79]
    ds_read_b64_tr_b16 v[134:135], v187 offset:13056
    v_mfma_f32_16x16x32_bf16 v[32:35], v[160:163], v[136:139], v[32:35]
    s_add_u32 s70, s72, 27648
    buffer_load_dwordx4 v192, s[8:11], s70 offen offset:3072 lds
    v_mfma_f32_16x16x32_bf16 v[36:39], v[160:163], v[140:143], v[36:39]
    v_mfma_f32_16x16x32_bf16 v[40:43], v[160:163], v[144:147], v[40:43]
    v_mfma_f32_16x16x32_bf16 v[44:47], v[160:163], v[148:151], v[44:47]
    v_mfma_f32_16x16x32_bf16 v[80:83], v[172:175], v[136:139], v[80:83]
    v_mfma_f32_16x16x32_bf16 v[84:87], v[172:175], v[140:143], v[84:87]
    s_add_u32 m0, s76, 0
    s_nop 0
    buffer_load_dwordx4 v193, s[12:15], s73 offen offset:0 lds
    v_mfma_f32_16x16x32_bf16 v[88:91], v[172:175], v[144:147], v[88:91]
    v_mfma_f32_16x16x32_bf16 v[92:95], v[172:175], v[148:151], v[92:95]
    s_waitcnt lgkmcnt(0)
    v_mfma_f32_16x16x32_bf16 v[0:3], v[112:115], v[96:99], v[0:3]
    ds_read_b128 v[136:139], v179 offset:0
    v_mfma_f32_16x16x32_bf16 v[4:7], v[112:115], v[100:103], v[4:7]
    buffer_load_dwordx4 v194, s[12:15], s73 offen offset:1024 lds
    ds_read_b64_tr_b16 v[152:153], v185 offset:6144
    v_mfma_f32_16x16x32_bf16 v[8:11], v[112:115], v[104:107], v[8:11]
    ds_read_b64_tr_b16 v[154:155], v185 offset:6912
    v_mfma_f32_16x16x32_bf16 v[12:15], v[112:115], v[108:111], v[12:15]
    ds_read_b128 v[140:143], v179 offset:2048
    v_mfma_f32_16x16x32_bf16 v[48:51], v[124:127], v[96:99], v[48:51]
    ds_read_b64_tr_b16 v[164:165], v185 offset:18432
    v_mfma_f32_16x16x32_bf16 v[52:55], v[124:127], v[100:103], v[52:55]
    ds_read_b64_tr_b16 v[166:167], v185 offset:19200
    v_mfma_f32_16x16x32_bf16 v[56:59], v[124:127], v[104:107], v[56:59]
    buffer_load_dwordx4 v195, s[12:15], s73 offen offset:2048 lds
    ds_read_b128 v[144:147], v179 offset:4096
    v_mfma_f32_16x16x32_bf16 v[60:63], v[124:127], v[108:111], v[60:63]
    ds_read_b128 v[148:151], v179 offset:6144
    v_mfma_f32_16x16x32_bf16 v[16:19], v[116:119], v[96:99], v[16:19]
    ds_read_b64_tr_b16 v[156:157], v186 offset:6144
    v_mfma_f32_16x16x32_bf16 v[20:23], v[116:119], v[100:103], v[20:23]
    ds_read_b64_tr_b16 v[158:159], v186 offset:6912
    v_mfma_f32_16x16x32_bf16 v[24:27], v[116:119], v[104:107], v[24:27]
    ds_read_b64_tr_b16 v[160:161], v187 offset:6144
    v_mfma_f32_16x16x32_bf16 v[28:31], v[116:119], v[108:111], v[28:31]
    s_add_u32 m0, s77, 0
    s_nop 0
    buffer_load_dwordx4 v193, s[16:19], s73 offen offset:0 lds
    ds_read_b64_tr_b16 v[162:163], v187 offset:6912
    v_mfma_f32_16x16x32_bf16 v[64:67], v[128:131], v[96:99], v[64:67]
    ds_read_b64_tr_b16 v[168:169], v186 offset:18432
    v_mfma_f32_16x16x32_bf16 v[68:71], v[128:131], v[100:103], v[68:71]
    ds_read_b64_tr_b16 v[170:171], v186 offset:19200
    v_mfma_f32_16x16x32_bf16 v[72:75], v[128:131], v[104:107], v[72:75]
    ds_read_b64_tr_b16 v[172:173], v187 offset:18432
    v_mfma_f32_16x16x32_bf16 v[76:79], v[128:131], v[108:111], v[76:79]
    ds_read_b64_tr_b16 v[174:175], v187 offset:19200
    v_mfma_f32_16x16x32_bf16 v[32:35], v[120:123], v[96:99], v[32:35]
    buffer_load_dwordx4 v194, s[16:19], s73 offen offset:1024 lds
    v_mfma_f32_16x16x32_bf16 v[36:39], v[120:123], v[100:103], v[36:39]
    v_mfma_f32_16x16x32_bf16 v[40:43], v[120:123], v[104:107], v[40:43]
    v_mfma_f32_16x16x32_bf16 v[44:47], v[120:123], v[108:111], v[44:47]
    v_mfma_f32_16x16x32_bf16 v[80:83], v[132:135], v[96:99], v[80:83]
    v_mfma_f32_16x16x32_bf16 v[84:87], v[132:135], v[100:103], v[84:87]
    buffer_load_dwordx4 v195, s[16:19], s73 offen offset:2048 lds
    v_mfma_f32_16x16x32_bf16 v[88:91], v[132:135], v[104:107], v[88:91]
    v_mfma_f32_16x16x32_bf16 v[92:95], v[132:135], v[108:111], v[92:95]
    s_waitcnt vmcnt(10) lgkmcnt(0)
    s_barrier
    v_mfma_f32_16x16x32_bf16 v[0:3], v[152:155], v[136:139], v[0:3]
    ds_read_b128 v[96:99], v180 offset:0
    v_mfma_f32_16x16x32_bf16 v[4:7], v[152:155], v[140:143], v[4:7]
    ds_read_b64_tr_b16 v[112:113], v188 offset:0
    v_mfma_f32_16x16x32_bf16 v[8:11], v[152:155], v[144:147], v[8:11]
    ds_read_b64_tr_b16 v[114:115], v188 offset:768
    v_mfma_f32_16x16x32_bf16 v[12:15], v[152:155], v[148:151], v[12:15]
    ds_read_b128 v[100:103], v180 offset:2048
    v_mfma_f32_16x16x32_bf16 v[48:51], v[164:167], v[136:139], v[48:51]
    ds_read_b64_tr_b16 v[124:125], v188 offset:12288
    v_mfma_f32_16x16x32_bf16 v[52:55], v[164:167], v[140:143], v[52:55]
    ds_read_b64_tr_b16 v[126:127], v188 offset:13056
    v_mfma_f32_16x16x32_bf16 v[56:59], v[164:167], v[144:147], v[56:59]
    ds_read_b128 v[104:107], v180 offset:4096
    v_mfma_f32_16x16x32_bf16 v[60:63], v[164:167], v[148:151], v[60:63]
    ds_read_b128 v[108:111], v180 offset:6144
    v_mfma_f32_16x16x32_bf16 v[16:19], v[156:159], v[136:139], v[16:19]
    ds_read_b64_tr_b16 v[116:117], v189 offset:0
    v_mfma_f32_16x16x32_bf16 v[20:23], v[156:159], v[140:143], v[20:23]
    ds_read_b64_tr_b16 v[118:119], v189 offset:768
    v_mfma_f32_16x16x32_bf16 v[24:27], v[156:159], v[144:147], v[24:27]
    ds_read_b64_tr_b16 v[120:121], v190 offset:0
    v_mfma_f32_16x16x32_bf16 v[28:31], v[156:159], v[148:151], v[28:31]
    ds_read_b64_tr_b16 v[122:123], v190 offset:768
    v_mfma_f32_16x16x32_bf16 v[64:67], v[168:171], v[136:139], v[64:67]
    ds_read_b64_tr_b16 v[128:129], v189 offset:12288
    v_mfma_f32_16x16x32_bf16 v[68:71], v[168:171], v[140:143], v[68:71]
    ds_read_b64_tr_b16 v[130:131], v189 offset:13056
    v_mfma_f32_16x16x32_bf16 v[72:75], v[168:171], v[144:147], v[72:75]
    ds_read_b64_tr_b16 v[132:133], v190 offset:12288
    v_mfma_f32_16x16x32_bf16 v[76:79], v[168:171], v[148:151], v[76:79]
    ds_read_b64_tr_b16 v[134:135], v190 offset:13056
    v_mfma_f32_16x16x32_bf16 v[32:35], v[160:163], v[136:139], v[32:35]
    v_mfma_f32_16x16x32_bf16 v[36:39], v[160:163], v[140:143], v[36:39]
    v_mfma_f32_16x16x32_bf16 v[40:43], v[160:163], v[144:147], v[40:43]
    v_mfma_f32_16x16x32_bf16 v[44:47], v[160:163], v[148:151], v[44:47]
    v_mfma_f32_16x16x32_bf16 v[80:83], v[172:175], v[136:139], v[80:83]
    v_mfma_f32_16x16x32_bf16 v[84:87], v[172:175], v[140:143], v[84:87]
    v_mfma_f32_16x16x32_bf16 v[88:91], v[172:175], v[144:147], v[88:91]
    v_mfma_f32_16x16x32_bf16 v[92:95], v[172:175], v[148:151], v[92:95]
    s_waitcnt lgkmcnt(0)
    v_mfma_f32_16x16x32_bf16 v[0:3], v[112:115], v[96:99], v[0:3]
    ds_read_b128 v[136:139], v181 offset:0
    v_mfma_f32_16x16x32_bf16 v[4:7], v[112:115], v[100:103], v[4:7]
    ds_read_b64_tr_b16 v[152:153], v188 offset:6144
    v_mfma_f32_16x16x32_bf16 v[8:11], v[112:115], v[104:107], v[8:11]
    ds_read_b64_tr_b16 v[154:155], v188 offset:6912
    v_mfma_f32_16x16x32_bf16 v[12:15], v[112:115], v[108:111], v[12:15]
    ds_read_b128 v[140:143], v181 offset:2048
    v_mfma_f32_16x16x32_bf16 v[48:51], v[124:127], v[96:99], v[48:51]
    ds_read_b64_tr_b16 v[164:165], v188 offset:18432
    v_mfma_f32_16x16x32_bf16 v[52:55], v[124:127], v[100:103], v[52:55]
    ds_read_b64_tr_b16 v[166:167], v188 offset:19200
    v_mfma_f32_16x16x32_bf16 v[56:59], v[124:127], v[104:107], v[56:59]
    ds_read_b128 v[144:147], v181 offset:4096
    v_mfma_f32_16x16x32_bf16 v[60:63], v[124:127], v[108:111], v[60:63]
    ds_read_b128 v[148:151], v181 offset:6144
    v_mfma_f32_16x16x32_bf16 v[16:19], v[116:119], v[96:99], v[16:19]
    ds_read_b64_tr_b16 v[156:157], v189 offset:6144
    v_mfma_f32_16x16x32_bf16 v[20:23], v[116:119], v[100:103], v[20:23]
    ds_read_b64_tr_b16 v[158:159], v189 offset:6912
    v_mfma_f32_16x16x32_bf16 v[24:27], v[116:119], v[104:107], v[24:27]
    ds_read_b64_tr_b16 v[160:161], v190 offset:6144
    v_mfma_f32_16x16x32_bf16 v[28:31], v[116:119], v[108:111], v[28:31]
    ds_read_b64_tr_b16 v[162:163], v190 offset:6912
    v_mfma_f32_16x16x32_bf16 v[64:67], v[128:131], v[96:99], v[64:67]
    ds_read_b64_tr_b16 v[168:169], v189 offset:18432
    v_mfma_f32_16x16x32_bf16 v[68:71], v[128:131], v[100:103], v[68:71]
    ds_read_b64_tr_b16 v[170:171], v189 offset:19200
    v_mfma_f32_16x16x32_bf16 v[72:75], v[128:131], v[104:107], v[72:75]
    ds_read_b64_tr_b16 v[172:173], v190 offset:18432
    v_mfma_f32_16x16x32_bf16 v[76:79], v[128:131], v[108:111], v[76:79]
    ds_read_b64_tr_b16 v[174:175], v190 offset:19200
    v_mfma_f32_16x16x32_bf16 v[32:35], v[120:123], v[96:99], v[32:35]
    v_mfma_f32_16x16x32_bf16 v[36:39], v[120:123], v[100:103], v[36:39]
    v_mfma_f32_16x16x32_bf16 v[40:43], v[120:123], v[104:107], v[40:43]
    v_mfma_f32_16x16x32_bf16 v[44:47], v[120:123], v[108:111], v[44:47]
    v_mfma_f32_16x16x32_bf16 v[80:83], v[132:135], v[96:99], v[80:83]
    v_mfma_f32_16x16x32_bf16 v[84:87], v[132:135], v[100:103], v[84:87]
    v_mfma_f32_16x16x32_bf16 v[88:91], v[132:135], v[104:107], v[88:91]
    v_mfma_f32_16x16x32_bf16 v[92:95], v[132:135], v[108:111], v[92:95]
    s_waitcnt vmcnt(0) lgkmcnt(0)
    s_barrier
    v_mfma_f32_16x16x32_bf16 v[0:3], v[152:155], v[136:139], v[0:3]
    ds_read_b128 v[96:99], v176 offset:0
    v_mfma_f32_16x16x32_bf16 v[4:7], v[152:155], v[140:143], v[4:7]
    ds_read_b64_tr_b16 v[112:113], v182 offset:0
    v_mfma_f32_16x16x32_bf16 v[8:11], v[152:155], v[144:147], v[8:11]
    ds_read_b64_tr_b16 v[114:115], v182 offset:768
    v_mfma_f32_16x16x32_bf16 v[12:15], v[152:155], v[148:151], v[12:15]
    ds_read_b128 v[100:103], v176 offset:2048
    v_mfma_f32_16x16x32_bf16 v[48:51], v[164:167], v[136:139], v[48:51]
    ds_read_b64_tr_b16 v[124:125], v182 offset:12288
    v_mfma_f32_16x16x32_bf16 v[52:55], v[164:167], v[140:143], v[52:55]
    ds_read_b64_tr_b16 v[126:127], v182 offset:13056
    v_mfma_f32_16x16x32_bf16 v[56:59], v[164:167], v[144:147], v[56:59]
    ds_read_b128 v[104:107], v176 offset:4096
    v_mfma_f32_16x16x32_bf16 v[60:63], v[164:167], v[148:151], v[60:63]
    ds_read_b128 v[108:111], v176 offset:6144
    v_mfma_f32_16x16x32_bf16 v[16:19], v[156:159], v[136:139], v[16:19]
    ds_read_b64_tr_b16 v[116:117], v183 offset:0
    v_mfma_f32_16x16x32_bf16 v[20:23], v[156:159], v[140:143], v[20:23]
    ds_read_b64_tr_b16 v[118:119], v183 offset:768
    v_mfma_f32_16x16x32_bf16 v[24:27], v[156:159], v[144:147], v[24:27]
    ds_read_b64_tr_b16 v[120:121], v184 offset:0
    v_mfma_f32_16x16x32_bf16 v[28:31], v[156:159], v[148:151], v[28:31]
    ds_read_b64_tr_b16 v[122:123], v184 offset:768
    v_mfma_f32_16x16x32_bf16 v[64:67], v[168:171], v[136:139], v[64:67]
    ds_read_b64_tr_b16 v[128:129], v183 offset:12288
    v_mfma_f32_16x16x32_bf16 v[68:71], v[168:171], v[140:143], v[68:71]
    ds_read_b64_tr_b16 v[130:131], v183 offset:13056
    v_mfma_f32_16x16x32_bf16 v[72:75], v[168:171], v[144:147], v[72:75]
    ds_read_b64_tr_b16 v[132:133], v184 offset:12288
    v_mfma_f32_16x16x32_bf16 v[76:79], v[168:171], v[148:151], v[76:79]
    ds_read_b64_tr_b16 v[134:135], v184 offset:13056
    v_mfma_f32_16x16x32_bf16 v[32:35], v[160:163], v[136:139], v[32:35]
    v_mfma_f32_16x16x32_bf16 v[36:39], v[160:163], v[140:143], v[36:39]
    v_mfma_f32_16x16x32_bf16 v[40:43], v[160:163], v[144:147], v[40:43]
    v_mfma_f32_16x16x32_bf16 v[44:47], v[160:163], v[148:151], v[44:47]
    v_mfma_f32_16x16x32_bf16 v[80:83], v[172:175], v[136:139], v[80:83]
    v_mfma_f32_16x16x32_bf16 v[84:87], v[172:175], v[140:143], v[84:87]
    v_mfma_f32_16x16x32_bf16 v[88:91], v[172:175], v[144:147], v[88:91]
    v_mfma_f32_16x16x32_bf16 v[92:95], v[172:175], v[148:151], v[92:95]
    s_waitcnt lgkmcnt(0)
    v_mfma_f32_16x16x32_bf16 v[0:3], v[112:115], v[96:99], v[0:3]
    ds_read_b128 v[136:139], v177 offset:0
    v_mfma_f32_16x16x32_bf16 v[4:7], v[112:115], v[100:103], v[4:7]
    ds_read_b64_tr_b16 v[152:153], v182 offset:6144
    v_mfma_f32_16x16x32_bf16 v[8:11], v[112:115], v[104:107], v[8:11]
    ds_read_b64_tr_b16 v[154:155], v182 offset:6912
    v_mfma_f32_16x16x32_bf16 v[12:15], v[112:115], v[108:111], v[12:15]
    ds_read_b128 v[140:143], v177 offset:2048
    v_mfma_f32_16x16x32_bf16 v[48:51], v[124:127], v[96:99], v[48:51]
    ds_read_b64_tr_b16 v[164:165], v182 offset:18432
    v_mfma_f32_16x16x32_bf16 v[52:55], v[124:127], v[100:103], v[52:55]
    ds_read_b64_tr_b16 v[166:167], v182 offset:19200
    v_mfma_f32_16x16x32_bf16 v[56:59], v[124:127], v[104:107], v[56:59]
    ds_read_b128 v[144:147], v177 offset:4096
    v_mfma_f32_16x16x32_bf16 v[60:63], v[124:127], v[108:111], v[60:63]
    ds_read_b128 v[148:151], v177 offset:6144
    v_mfma_f32_16x16x32_bf16 v[16:19], v[116:119], v[96:99], v[16:19]
    ds_read_b64_tr_b16 v[156:157], v183 offset:6144
    v_mfma_f32_16x16x32_bf16 v[20:23], v[116:119], v[100:103], v[20:23]
    ds_read_b64_tr_b16 v[158:159], v183 offset:6912
    v_mfma_f32_16x16x32_bf16 v[24:27], v[116:119], v[104:107], v[24:27]
    ds_read_b64_tr_b16 v[160:161], v184 offset:6144
    v_mfma_f32_16x16x32_bf16 v[28:31], v[116:119], v[108:111], v[28:31]
    ds_read_b64_tr_b16 v[162:163], v184 offset:6912
    v_mfma_f32_16x16x32_bf16 v[64:67], v[128:131], v[96:99], v[64:67]
    ds_read_b64_tr_b16 v[168:169], v183 offset:18432
    v_mfma_f32_16x16x32_bf16 v[68:71], v[128:131], v[100:103], v[68:71]
    ds_read_b64_tr_b16 v[170:171], v183 offset:19200
    v_mfma_f32_16x16x32_bf16 v[72:75], v[128:131], v[104:107], v[72:75]
    ds_read_b64_tr_b16 v[172:173], v184 offset:18432
    v_mfma_f32_16x16x32_bf16 v[76:79], v[128:131], v[108:111], v[76:79]
    ds_read_b64_tr_b16 v[174:175], v184 offset:19200
    v_mfma_f32_16x16x32_bf16 v[32:35], v[120:123], v[96:99], v[32:35]
    v_mfma_f32_16x16x32_bf16 v[36:39], v[120:123], v[100:103], v[36:39]
    v_mfma_f32_16x16x32_bf16 v[40:43], v[120:123], v[104:107], v[40:43]
    v_mfma_f32_16x16x32_bf16 v[44:47], v[120:123], v[108:111], v[44:47]
    v_mfma_f32_16x16x32_bf16 v[80:83], v[132:135], v[96:99], v[80:83]
    v_mfma_f32_16x16x32_bf16 v[84:87], v[132:135], v[100:103], v[84:87]
    v_mfma_f32_16x16x32_bf16 v[88:91], v[132:135], v[104:107], v[88:91]
    v_mfma_f32_16x16x32_bf16 v[92:95], v[132:135], v[108:111], v[92:95]
    s_waitcnt lgkmcnt(0)
    v_mov_b32 v200, 161696
    v_mov_b32 v201, 1
    s_mov_b64 exec, 1
    ds_add_u32 v200, v201
    s_mov_b64 exec, -1
    v_mfma_f32_16x16x32_bf16 v[0:3], v[152:155], v[136:139], v[0:3]
    v_mfma_f32_16x16x32_bf16 v[4:7], v[152:155], v[140:143], v[4:7]
    v_mfma_f32_16x16x32_bf16 v[8:11], v[152:155], v[144:147], v[8:11]
    v_mfma_f32_16x16x32_bf16 v[12:15], v[152:155], v[148:151], v[12:15]
    v_mfma_f32_16x16x32_bf16 v[48:51], v[164:167], v[136:139], v[48:51]
    v_mfma_f32_16x16x32_bf16 v[52:55], v[164:167], v[140:143], v[52:55]
    v_mfma_f32_16x16x32_bf16 v[56:59], v[164:167], v[144:147], v[56:59]
    v_mfma_f32_16x16x32_bf16 v[60:63], v[164:167], v[148:151], v[60:63]
    v_mfma_f32_16x16x32_bf16 v[16:19], v[156:159], v[136:139], v[16:19]
    v_mfma_f32_16x16x32_bf16 v[20:23], v[156:159], v[140:143], v[20:23]
    v_mfma_f32_16x16x32_bf16 v[24:27], v[156:159], v[144:147], v[24:27]
    v_mfma_f32_16x16x32_bf16 v[28:31], v[156:159], v[148:151], v[28:31]
    v_mfma_f32_16x16x32_bf16 v[64:67], v[168:171], v[136:139], v[64:67]
    v_mfma_f32_16x16x32_bf16 v[68:71], v[168:171], v[140:143], v[68:71]
    v_mfma_f32_16x16x32_bf16 v[72:75], v[168:171], v[144:147], v[72:75]
    v_mfma_f32_16x16x32_bf16 v[76:79], v[168:171], v[148:151], v[76:79]
    v_mfma_f32_16x16x32_bf16 v[32:35], v[160:163], v[136:139], v[32:35]
    v_mfma_f32_16x16x32_bf16 v[36:39], v[160:163], v[140:143], v[36:39]
    v_mfma_f32_16x16x32_bf16 v[40:43], v[160:163], v[144:147], v[40:43]
    v_mfma_f32_16x16x32_bf16 v[44:47], v[160:163], v[148:151], v[44:47]
    v_mfma_f32_16x16x32_bf16 v[80:83], v[172:175], v[136:139], v[80:83]
    v_mfma_f32_16x16x32_bf16 v[84:87], v[172:175], v[140:143], v[84:87]
    v_mfma_f32_16x16x32_bf16 v[88:91], v[172:175], v[144:147], v[88:91]
    v_mfma_f32_16x16x32_bf16 v[92:95], v[172:175], v[148:151], v[92:95]
    v_mov_b32 v96, 0xbfb8aa3b
    v_mov_b32 v97, 0xbfb8aa3b
    v_mov_b32 v98, 1.0
    v_mov_b32 v99, 1.0
    v_pk_mul_f32 v[136:137], v[0:1], v[96:97]
    v_pk_mul_f32 v[138:139], v[2:3], v[96:97]
    v_pk_mul_f32 v[140:141], v[16:17], v[96:97]
    v_pk_mul_f32 v[142:143], v[18:19], v[96:97]
    v_exp_f32 v136, v136
    v_exp_f32 v137, v137
    v_exp_f32 v138, v138
    v_exp_f32 v139, v139
    v_exp_f32 v140, v140
    v_exp_f32 v141, v141
    v_exp_f32 v142, v142
    v_exp_f32 v143, v143
    v_pk_mul_f32 v[0:1], v[0:1], v[48:49]
    v_pk_mul_f32 v[2:3], v[2:3], v[50:51]
    v_pk_mul_f32 v[16:17], v[16:17], v[64:65]
    v_pk_mul_f32 v[18:19], v[18:19], v[66:67]
    v_pk_add_f32 v[136:137], v[136:137], v[98:99]
    v_pk_add_f32 v[138:139], v[138:139], v[98:99]
    v_pk_add_f32 v[140:141], v[140:141], v[98:99]
    v_pk_add_f32 v[142:143], v[142:143], v[98:99]
    v_rcp_f32 v136, v136
    v_rcp_f32 v137, v137
    v_rcp_f32 v138, v138
    v_rcp_f32 v139, v139
    v_rcp_f32 v140, v140
    v_rcp_f32 v141, v141
    v_rcp_f32 v142, v142
    v_rcp_f32 v143, v143
    v_pk_mul_f32 v[0:1], v[0:1], v[136:137]
    v_pk_mul_f32 v[2:3], v[2:3], v[138:139]
    v_pk_mul_f32 v[16:17], v[16:17], v[140:141]
    v_pk_mul_f32 v[18:19], v[18:19], v[142:143]
    v_cvt_pk_bf16_f32 v104, v0, v1
    v_cvt_pk_bf16_f32 v105, v2, v3
    v_cvt_pk_bf16_f32 v106, v16, v17
    v_cvt_pk_bf16_f32 v107, v18, v19
    buffer_store_dwordx4 v[104:107], v196, s[20:23], s78 offen offset:0 sc1
    v_pk_mul_f32 v[152:153], v[32:33], v[96:97]
    v_pk_mul_f32 v[154:155], v[34:35], v[96:97]
    v_exp_f32 v152, v152
    v_exp_f32 v153, v153
    v_exp_f32 v154, v154
    v_exp_f32 v155, v155
    v_pk_mul_f32 v[32:33], v[32:33], v[80:81]
    v_pk_mul_f32 v[34:35], v[34:35], v[82:83]
    v_pk_add_f32 v[152:153], v[152:153], v[98:99]
    v_pk_add_f32 v[154:155], v[154:155], v[98:99]
    v_rcp_f32 v152, v152
    v_rcp_f32 v153, v153
    v_rcp_f32 v154, v154
    v_rcp_f32 v155, v155
    v_pk_mul_f32 v[32:33], v[32:33], v[152:153]
    v_pk_mul_f32 v[34:35], v[34:35], v[154:155]
    v_cvt_pk_bf16_f32 v108, v32, v33
    v_cvt_pk_bf16_f32 v109, v34, v35
    buffer_store_dwordx2 v[108:109], v198, s[20:23], s79 offen offset:0 sc1
    v_pk_mul_f32 v[136:137], v[4:5], v[96:97]
    v_pk_mul_f32 v[138:139], v[6:7], v[96:97]
    v_pk_mul_f32 v[140:141], v[20:21], v[96:97]
    v_pk_mul_f32 v[142:143], v[22:23], v[96:97]
    v_exp_f32 v136, v136
    v_exp_f32 v137, v137
    v_exp_f32 v138, v138
    v_exp_f32 v139, v139
    v_exp_f32 v140, v140
    v_exp_f32 v141, v141
    v_exp_f32 v142, v142
    v_exp_f32 v143, v143
    v_pk_mul_f32 v[4:5], v[4:5], v[52:53]
    v_pk_mul_f32 v[6:7], v[6:7], v[54:55]
    v_pk_mul_f32 v[20:21], v[20:21], v[68:69]
    v_pk_mul_f32 v[22:23], v[22:23], v[70:71]
    v_pk_add_f32 v[136:137], v[136:137], v[98:99]
    v_pk_add_f32 v[138:139], v[138:139], v[98:99]
    v_pk_add_f32 v[140:141], v[140:141], v[98:99]
    v_pk_add_f32 v[142:143], v[142:143], v[98:99]
    v_rcp_f32 v136, v136
    v_rcp_f32 v137, v137
    v_rcp_f32 v138, v138
    v_rcp_f32 v139, v139
    v_rcp_f32 v140, v140
    v_rcp_f32 v141, v141
    v_rcp_f32 v142, v142
    v_rcp_f32 v143, v143
    v_pk_mul_f32 v[4:5], v[4:5], v[136:137]
    v_pk_mul_f32 v[6:7], v[6:7], v[138:139]
    v_pk_mul_f32 v[20:21], v[20:21], v[140:141]
    v_pk_mul_f32 v[22:23], v[22:23], v[142:143]
    v_cvt_pk_bf16_f32 v112, v4, v5
    v_cvt_pk_bf16_f32 v113, v6, v7
    v_cvt_pk_bf16_f32 v114, v20, v21
    v_cvt_pk_bf16_f32 v115, v22, v23
    buffer_store_dwordx4 v[112:115], v196, s[20:23], s78 offen offset:1024 sc1
    v_pk_mul_f32 v[152:153], v[36:37], v[96:97]
    v_pk_mul_f32 v[154:155], v[38:39], v[96:97]
    v_exp_f32 v152, v152
    v_exp_f32 v153, v153
    v_exp_f32 v154, v154
    v_exp_f32 v155, v155
    v_pk_mul_f32 v[36:37], v[36:37], v[84:85]
    v_pk_mul_f32 v[38:39], v[38:39], v[86:87]
    v_pk_add_f32 v[152:153], v[152:153], v[98:99]
    v_pk_add_f32 v[154:155], v[154:155], v[98:99]
    v_rcp_f32 v152, v152
    v_rcp_f32 v153, v153
    v_rcp_f32 v154, v154
    v_rcp_f32 v155, v155
    v_pk_mul_f32 v[36:37], v[36:37], v[152:153]
    v_pk_mul_f32 v[38:39], v[38:39], v[154:155]
    v_cvt_pk_bf16_f32 v116, v36, v37
    v_cvt_pk_bf16_f32 v117, v38, v39
    buffer_store_dwordx2 v[116:117], v198, s[20:23], s79 offen offset:1024 sc1
    v_pk_mul_f32 v[136:137], v[8:9], v[96:97]
    v_pk_mul_f32 v[138:139], v[10:11], v[96:97]
    v_pk_mul_f32 v[140:141], v[24:25], v[96:97]
    v_pk_mul_f32 v[142:143], v[26:27], v[96:97]
    v_exp_f32 v136, v136
    v_exp_f32 v137, v137
    v_exp_f32 v138, v138
    v_exp_f32 v139, v139
    v_exp_f32 v140, v140
    v_exp_f32 v141, v141
    v_exp_f32 v142, v142
    v_exp_f32 v143, v143
    v_pk_mul_f32 v[8:9], v[8:9], v[56:57]
    v_pk_mul_f32 v[10:11], v[10:11], v[58:59]
    v_pk_mul_f32 v[24:25], v[24:25], v[72:73]
    v_pk_mul_f32 v[26:27], v[26:27], v[74:75]
    v_pk_add_f32 v[136:137], v[136:137], v[98:99]
    v_pk_add_f32 v[138:139], v[138:139], v[98:99]
    v_pk_add_f32 v[140:141], v[140:141], v[98:99]
    v_pk_add_f32 v[142:143], v[142:143], v[98:99]
    v_rcp_f32 v136, v136
    v_rcp_f32 v137, v137
    v_rcp_f32 v138, v138
    v_rcp_f32 v139, v139
    v_rcp_f32 v140, v140
    v_rcp_f32 v141, v141
    v_rcp_f32 v142, v142
    v_rcp_f32 v143, v143
    v_pk_mul_f32 v[8:9], v[8:9], v[136:137]
    v_pk_mul_f32 v[10:11], v[10:11], v[138:139]
    v_pk_mul_f32 v[24:25], v[24:25], v[140:141]
    v_pk_mul_f32 v[26:27], v[26:27], v[142:143]
    v_cvt_pk_bf16_f32 v104, v8, v9
    v_cvt_pk_bf16_f32 v105, v10, v11
    v_cvt_pk_bf16_f32 v106, v24, v25
    v_cvt_pk_bf16_f32 v107, v26, v27
    buffer_store_dwordx4 v[104:107], v196, s[20:23], s78 offen offset:2048 sc1
    v_pk_mul_f32 v[152:153], v[40:41], v[96:97]
    v_pk_mul_f32 v[154:155], v[42:43], v[96:97]
    v_exp_f32 v152, v152
    v_exp_f32 v153, v153
    v_exp_f32 v154, v154
    v_exp_f32 v155, v155
    v_pk_mul_f32 v[40:41], v[40:41], v[88:89]
    v_pk_mul_f32 v[42:43], v[42:43], v[90:91]
    v_pk_add_f32 v[152:153], v[152:153], v[98:99]
    v_pk_add_f32 v[154:155], v[154:155], v[98:99]
    v_rcp_f32 v152, v152
    v_rcp_f32 v153, v153
    v_rcp_f32 v154, v154
    v_rcp_f32 v155, v155
    v_pk_mul_f32 v[40:41], v[40:41], v[152:153]
    v_pk_mul_f32 v[42:43], v[42:43], v[154:155]
    v_cvt_pk_bf16_f32 v108, v40, v41
    v_cvt_pk_bf16_f32 v109, v42, v43
    buffer_store_dwordx2 v[108:109], v198, s[20:23], s79 offen offset:2048 sc1
    v_pk_mul_f32 v[136:137], v[12:13], v[96:97]
    v_pk_mul_f32 v[138:139], v[14:15], v[96:97]
    v_pk_mul_f32 v[140:141], v[28:29], v[96:97]
    v_pk_mul_f32 v[142:143], v[30:31], v[96:97]
    v_exp_f32 v136, v136
    v_exp_f32 v137, v137
    v_exp_f32 v138, v138
    v_exp_f32 v139, v139
    v_exp_f32 v140, v140
    v_exp_f32 v141, v141
    v_exp_f32 v142, v142
    v_exp_f32 v143, v143
    v_pk_mul_f32 v[12:13], v[12:13], v[60:61]
    v_pk_mul_f32 v[14:15], v[14:15], v[62:63]
    v_pk_mul_f32 v[28:29], v[28:29], v[76:77]
    v_pk_mul_f32 v[30:31], v[30:31], v[78:79]
    v_pk_add_f32 v[136:137], v[136:137], v[98:99]
    v_pk_add_f32 v[138:139], v[138:139], v[98:99]
    v_pk_add_f32 v[140:141], v[140:141], v[98:99]
    v_pk_add_f32 v[142:143], v[142:143], v[98:99]
    v_rcp_f32 v136, v136
    v_rcp_f32 v137, v137
    v_rcp_f32 v138, v138
    v_rcp_f32 v139, v139
    v_rcp_f32 v140, v140
    v_rcp_f32 v141, v141
    v_rcp_f32 v142, v142
    v_rcp_f32 v143, v143
    v_pk_mul_f32 v[12:13], v[12:13], v[136:137]
    v_pk_mul_f32 v[14:15], v[14:15], v[138:139]
    v_pk_mul_f32 v[28:29], v[28:29], v[140:141]
    v_pk_mul_f32 v[30:31], v[30:31], v[142:143]
    v_cvt_pk_bf16_f32 v112, v12, v13
    v_cvt_pk_bf16_f32 v113, v14, v15
    v_cvt_pk_bf16_f32 v114, v28, v29
    v_cvt_pk_bf16_f32 v115, v30, v31
    buffer_store_dwordx4 v[112:115], v196, s[20:23], s78 offen offset:3072 sc1
    v_pk_mul_f32 v[152:153], v[44:45], v[96:97]
    v_pk_mul_f32 v[154:155], v[46:47], v[96:97]
    v_exp_f32 v152, v152
    v_exp_f32 v153, v153
    v_exp_f32 v154, v154
    v_exp_f32 v155, v155
    v_pk_mul_f32 v[44:45], v[44:45], v[92:93]
    v_pk_mul_f32 v[46:47], v[46:47], v[94:95]
    v_pk_add_f32 v[152:153], v[152:153], v[98:99]
    v_pk_add_f32 v[154:155], v[154:155], v[98:99]
    v_rcp_f32 v152, v152
    v_rcp_f32 v153, v153
    v_rcp_f32 v154, v154
    v_rcp_f32 v155, v155
    v_pk_mul_f32 v[44:45], v[44:45], v[152:153]
    v_pk_mul_f32 v[46:47], v[46:47], v[154:155]
    v_cvt_pk_bf16_f32 v116, v44, v45
    v_cvt_pk_bf16_f32 v117, v46, v47
    buffer_store_dwordx2 v[116:117], v198, s[20:23], s79 offen offset:3072 sc1
    v_mbcnt_lo_u32_b32 v230, -1, 0
    v_mbcnt_hi_u32_b32 v230, -1, v230
    v_lshlrev_b32 v228, 4, v230
    s_add_u32 s67, s3, 0
    s_and_b32 s67, s67, 3
    s_lshl_b32 s67, s67, 10
    v_add_u32 v224, s67, v228
    v_lshlrev_b32 v246, 3, v230
    v_add_u32 v246, s67, v246
    s_add_u32 s67, s3, 1
    s_and_b32 s67, s67, 3
    s_lshl_b32 s67, s67, 10
    v_add_u32 v225, s67, v228
    v_lshlrev_b32 v247, 3, v230
    v_add_u32 v247, s67, v247
    s_add_u32 s67, s3, 2
    s_and_b32 s67, s67, 3
    s_lshl_b32 s67, s67, 10
    v_add_u32 v226, s67, v228
    v_lshlrev_b32 v248, 3, v230
    v_add_u32 v248, s67, v248
    s_add_u32 s67, s3, 3
    s_and_b32 s67, s67, 3
    s_lshl_b32 s67, s67, 10
    v_add_u32 v227, s67, v228
    v_lshlrev_b32 v249, 3, v230
    v_add_u32 v249, s67, v249
    s_mul_i32 s70, s6, 48
    s_mul_i32 s67, s3, 12
    s_add_u32 s70, s70, s67
    s_lshl_b32 s70, s70, 12
    s_mul_i32 s71, s7, 48
    s_add_u32 s71, s71, s67
    s_mul_i32 s71, s71, 5120
    s_add_u32 s71, s71, 6291456
    s_add_u32 s72, s71, 4096
    s_add_u32 s67, s3, 1
    s_and_b32 s67, s67, 3
    s_mul_i32 s67, s67, 3
    s_add_u32 s67, s67, 0
    s_mul_i32 s67, s67, 5120
    s_add_u32 s67, s67, 57344
    v_add_u32 v250, s67, v228
    s_mov_b32 s73, s67
    s_add_u32 s67, s3, 2
    s_and_b32 s67, s67, 3
    s_mul_i32 s67, s67, 3
    s_add_u32 s67, s67, 1
    s_mul_i32 s67, s67, 5120
    s_add_u32 s67, s67, 57344
    v_add_u32 v251, s67, v228
    s_mov_b32 s74, s67
    s_add_u32 s67, s3, 3
    s_and_b32 s67, s67, 3
    s_mul_i32 s67, s67, 3
    s_add_u32 s67, s67, 2
    s_mul_i32 s67, s67, 5120
    s_add_u32 s67, s67, 57344
    v_add_u32 v252, s67, v228
    s_mov_b32 s75, s67
    v_mov_b32 v232, 161664
    ds_read_b32 v232, v232
    s_waitcnt lgkmcnt(0)
    v_readfirstlane_b32 s64, v232
    s_nop 1
    v_mov_b32 v254, 0
    s_cmp_lg_u32 s3, 0
    s_cbranch_scc1 L_gated__lk_3
    s_lshl_b32 s79, s7, 8
    s_add_u32 s79, s79, 14766080
    v_mbcnt_lo_u32_b32 v254, -1, 0
    v_mbcnt_hi_u32_b32 v254, -1, v254
    v_cmp_gt_u32 vcc, 48, v254
    v_lshlrev_b32 v254, 2, v254
    s_nop 0
    v_cndmask_b32 v254, 0, v254, vcc
    buffer_load_dword v255, v254, s[20:23], s79 offen sc1
    s_waitcnt vmcnt(1)
    s_branch L_gated__lk_4
L_gated__lk_3:
    s_waitcnt vmcnt(0)
L_gated__lk_4:
    v_mov_b32 v232, 161672
    v_mov_b32 v233, 1
    s_mov_b64 exec, 1
    ds_add_rtn_u32 v234, v232, v233
    s_waitcnt lgkmcnt(0)
    s_mov_b64 exec, -1
    v_readfirstlane_b32 s69, v234
    s_nop 1
    s_cmp_lg_u32 s69, 3
    s_cbranch_scc1 L_gated__fh_5
    s_lshl_b32 s69, s4, 5
    s_add_u32 s69, s69, s5
    s_lshl_b32 s69, s69, 2
    s_add_u32 s69, s69, 14749696
    v_mov_b32 v232, s64
    v_mov_b32 v233, 0
    s_mov_b64 exec, 1
    buffer_store_dword v232, v233, s[20:23], s69 offen sc1
    s_mov_b64 exec, -1
L_gated__fh_5:
    v_mov_b32 v232, 161696
    s_mov_b32 s69, 0
L_gated__ls_6:
    ds_read_b32 v233, v232
    s_waitcnt lgkmcnt(0)
    v_readfirstlane_b32 s78, v233
    s_nop 1
    s_cmp_eq_u32 s78, 4
    s_cbranch_scc1 L_gated__ld_7
    s_add_u32 s69, s69, 1
    s_cmp_lt_u32 s69, 0x400000
    s_cbranch_scc0 L_gated__ld_7
    s_sleep 1
    s_branch L_gated__ls_6
L_gated__ld_7:
    s_mov_b32 s67, 52429
    s_movk_i32 s68, 1280
    v_add_u32 v121, 0, v230
    v_mul_lo_u32 v122, v121, s67
    v_lshrrev_b32 v122, 19, v122
    v_mul_u32_u24 v123, 10, v122
    v_sub_u32 v123, v121, v123
    v_mul_lo_u32 v122, v122, s68
    v_lshl_add_u32 v116, v123, 4, v122
    v_add_u32 v121, 64, v230
    v_mul_lo_u32 v122, v121, s67
    v_lshrrev_b32 v122, 19, v122
    v_mul_u32_u24 v123, 10, v122
    v_sub_u32 v123, v121, v123
    v_mul_lo_u32 v122, v122, s68
    v_lshl_add_u32 v117, v123, 4, v122
    v_add_u32 v121, 128, v230
    v_mul_lo_u32 v122, v121, s67
    v_lshrrev_b32 v122, 19, v122
    v_mul_u32_u24 v123, 10, v122
    v_sub_u32 v123, v121, v123
    v_mul_lo_u32 v122, v122, s68
    v_lshl_add_u32 v118, v123, 4, v122
    v_add_u32 v121, 192, v230
    v_mul_lo_u32 v122, v121, s67
    v_lshrrev_b32 v122, 19, v122
    v_mul_u32_u24 v123, 10, v122
    v_sub_u32 v123, v121, v123
    v_mul_lo_u32 v122, v122, s68
    v_lshl_add_u32 v119, v123, 4, v122
    v_add_u32 v121, 256, v230
    v_mul_lo_u32 v122, v121, s67
    v_lshrrev_b32 v122, 19, v122
    v_mul_u32_u24 v123, 10, v122
    v_sub_u32 v123, v121, v123
    v_mul_lo_u32 v122, v122, s68
    v_lshl_add_u32 v120, v123, 4, v122
    v_lshrrev_b32 v121, 4, v230
    v_and_b32 v122, 15, v230
    v_lshrrev_b32 v122, 2, v122
    v_lshl_add_u32 v121, v121, 2, v122
    v_mul_u32_u24 v121, 160, v121
    v_and_b32 v122, 3, v230
    v_lshl_add_u32 v245, v122, 4, v121
    v_lshl_add_u32 v253, v122, 3, v121
    s_mul_i32 s67, s3, 12
    s_add_u32 s67, s67, 4
    s_mul_i32 s67, s67, 40960
    s_mul_i32 s68, s7, 160
    s_add_u32 s67, s67, s68
    s_add_u32 m0, s73, 0
    s_nop 0
    buffer_load_dwordx4 v116, s[28:31], s67 offen lds
    s_add_u32 m0, s73, 1024
    s_nop 0
    buffer_load_dwordx4 v117, s[28:31], s67 offen lds
    s_add_u32 m0, s73, 2048
    s_nop 0
    buffer_load_dwordx4 v118, s[28:31], s67 offen lds
    s_add_u32 m0, s73, 3072
    s_nop 0
    buffer_load_dwordx4 v119, s[28:31], s67 offen lds
    s_add_u32 m0, s73, 4096
    s_nop 0
    buffer_load_dwordx4 v120, s[28:31], s67 offen lds
    s_add_u32 s67, s67, 40960
    s_add_u32 m0, s74, 0
    s_nop 0
    buffer_load_dwordx4 v116, s[28:31], s67 offen lds
    s_add_u32 m0, s74, 1024
    s_nop 0
    buffer_load_dwordx4 v117, s[28:31], s67 offen lds
    s_add_u32 m0, s74, 2048
    s_nop 0
    buffer_load_dwordx4 v118, s[28:31], s67 offen lds
    s_add_u32 m0, s74, 3072
    s_nop 0
    buffer_load_dwordx4 v119, s[28:31], s67 offen lds
    s_add_u32 m0, s74, 4096
    s_nop 0
    buffer_load_dwordx4 v120, s[28:31], s67 offen lds
    s_add_u32 s67, s67, 40960
    s_add_u32 m0, s75, 0
    s_nop 0
    buffer_load_dwordx4 v116, s[28:31], s67 offen lds
    s_add_u32 m0, s75, 1024
    s_nop 0
    buffer_load_dwordx4 v117, s[28:31], s67 offen lds
    s_add_u32 m0, s75, 2048
    s_nop 0
    buffer_load_dwordx4 v118, s[28:31], s67 offen lds
    s_add_u32 m0, s75, 3072
    s_nop 0
    buffer_load_dwordx4 v119, s[28:31], s67 offen lds
    s_add_u32 m0, s75, 4096
    s_nop 0
    buffer_load_dwordx4 v120, s[28:31], s67 offen lds
    s_cmp_lg_u32 s3, 0
    s_cbranch_scc1 L_gated__ww_8
    v_mov_b32 v232, 161696
    s_mov_b32 s69, 0
L_gated__ls_10:
    ds_read_b32 v233, v232
    s_waitcnt lgkmcnt(0)
    v_readfirstlane_b32 s78, v233
    s_nop 1
    s_cmp_eq_u32 s78, 4
    s_cbranch_scc1 L_gated__ld_11
    s_add_u32 s69, s69, 1
    s_cmp_lt_u32 s69, 0x400000
    s_cbranch_scc0 L_gated__ld_11
    s_sleep 1
    s_branch L_gated__ls_10
L_gated__ld_11:
    v_mov_b32 v232, 161684
    s_mov_b32 s69, 0
L_gated__ls_12:
    ds_read_b32 v233, v232
    s_waitcnt lgkmcnt(0)
    v_readfirstlane_b32 s78, v233
    s_nop 1
    s_cmp_eq_u32 s78, 3
    s_cbranch_scc1 L_gated__ld_13
    s_add_u32 s69, s69, 1
    s_cmp_lt_u32 s69, 0x400000
    s_cbranch_scc0 L_gated__ld_13
    s_sleep 1
    s_branch L_gated__ls_12
L_gated__ld_13:
    s_waitcnt vmcnt(0)
    v_cmp_eq_u32 vcc, s64, v255
    s_nop 1
    s_cmp_eq_u64 vcc, -1
    s_cbranch_scc1 L_gated__ck_14
    s_mov_b32 s69, 0
L_gated__pl_15:
    buffer_load_dword v255, v254, s[20:23], s79 offen sc1
    s_waitcnt vmcnt(0)
    v_cmp_eq_u32 vcc, s64, v255
    s_nop 1
    s_cmp_eq_u64 vcc, -1
    s_cbranch_scc1 L_gated__pd_16
    s_add_u32 s69, s69, 1
    s_cmp_lt_u32 s69, 0x40000
    s_cbranch_scc0 L_gated__pd_16
    s_sleep 2
    s_branch L_gated__pl_15
L_gated__pd_16:
L_gated__ck_14:
    v_mov_b32 v232, 161680
    v_mov_b32 v233, 1
    ds_write_b32 v232, v233
    s_lshr_b32 s79, s6, 1
    s_lshl_b32 s79, s79, 7
    s_add_u32 s79, s79, 14749696
    v_mbcnt_lo_u32_b32 v254, -1, 0
    v_mbcnt_hi_u32_b32 v254, -1, v254
    v_cmp_gt_u32 vcc, 16, v254
    v_lshlrev_b32 v254, 2, v254
    s_nop 0
    v_cndmask_b32 v254, 0, v254, vcc
    buffer_load_dword v255, v254, s[20:23], s79 offen sc1
    s_branch L_gated__wd_9
L_gated__ww_8:
    v_mov_b32 v232, 161680
    s_mov_b32 s69, 0
L_gated__ls_17:
    ds_read_b32 v233, v232
    s_waitcnt lgkmcnt(0)
    v_readfirstlane_b32 s78, v233
    s_nop 1
    s_cmp_eq_u32 s78, 1
    s_cbranch_scc1 L_gated__ld_18
    s_add_u32 s69, s69, 1
    s_cmp_lt_u32 s69, 0x400000
    s_cbranch_scc0 L_gated__ld_18
    s_sleep 1
    s_branch L_gated__ls_17
L_gated__ld_18:
L_gated__wd_9:
    buffer_load_dwordx4 v[96:99], v228, s[20:23], s71 offen offset:0 sc1
    buffer_load_dwordx4 v[100:103], v228, s[20:23], s71 offen offset:1024 sc1
    buffer_load_dwordx4 v[104:107], v228, s[20:23], s71 offen offset:2048 sc1
    buffer_load_dwordx4 v[108:111], v228, s[20:23], s71 offen offset:3072 sc1
    buffer_load_dwordx4 v[112:115], v228, s[20:23], s72 offen sc1
    s_add_u32 s71, s71, 5120
    s_add_u32 s72, s72, 5120
    buffer_load_dwordx4 v[132:135], v228, s[20:23], s71 offen offset:0 sc1
    buffer_load_dwordx4 v[136:139], v228, s[20:23], s71 offen offset:1024 sc1
    buffer_load_dwordx4 v[140:143], v228, s[20:23], s71 offen offset:2048 sc1
    buffer_load_dwordx4 v[144:147], v228, s[20:23], s71 offen offset:3072 sc1
    buffer_load_dwordx4 v[148:151], v228, s[20:23], s72 offen sc1
    s_add_u32 s71, s71, 5120
    s_add_u32 s72, s72, 5120
    buffer_load_dwordx4 v[168:171], v228, s[20:23], s71 offen offset:0 sc1
    buffer_load_dwordx4 v[172:175], v228, s[20:23], s71 offen offset:1024 sc1
    buffer_load_dwordx4 v[176:179], v228, s[20:23], s71 offen offset:2048 sc1
    buffer_load_dwordx4 v[180:183], v228, s[20:23], s71 offen offset:3072 sc1
    buffer_load_dwordx4 v[184:187], v228, s[20:23], s72 offen sc1
    s_add_u32 s71, s71, 5120
    s_add_u32 s72, s72, 5120
    buffer_load_dwordx4 v[204:207], v228, s[20:23], s71 offen offset:0 sc1
    buffer_load_dwordx4 v[208:211], v228, s[20:23], s71 offen offset:1024 sc1
    buffer_load_dwordx4 v[212:215], v228, s[20:23], s71 offen offset:2048 sc1
    buffer_load_dwordx4 v[216:219], v228, s[20:23], s71 offen offset:3072 sc1
    buffer_load_dwordx4 v[220:223], v228, s[20:23], s72 offen sc1
    s_add_u32 s71, s71, 5120
    s_add_u32 s72, s72, 5120
    s_add_u32 s71, s71, 15360
    s_add_u32 s72, s72, 15360
    s_mul_i32 s67, s3, 15360
    s_add_u32 s67, s67, 57344
    v_add_u32 v231, s67, v228
    v_lshrrev_b32 v232, 4, v230
    v_and_b32 v233, 15, v230
    v_lshrrev_b32 v234, 2, v233
    v_lshl_add_u32 v235, v232, 3, v234
    v_lshl_add_u32 v236, v232, 2, v234
    v_and_b32 v237, 3, v230
    v_lshlrev_b32 v237, 3, v237
    s_lshl_b32 s67, s3, 5
    s_add_u32 s67, s67, 122880
    v_add_u32 v237, s67, v237
    v_lshl_add_u32 v235, v235, 7, v237
    v_lshl_add_u32 v236, v236, 7, v237
    s_lshl_b32 s67, s3, 6
    s_add_u32 s67, s67, 161728
    v_lshl_add_u32 v238, v233, 2, s67
    s_lshl_b32 s67, s6, 6
    s_lshl_b32 s68, s3, 4
    s_add_u32 s67, s67, s68
    v_add_u32 v239, s67, v233
    s_movk_i32 s68, 1280
    v_mul_lo_u32 v239, v239, s68
    s_mul_i32 s68, s7, 160
    v_add_u32 v239, s68, v239
    v_lshl_add_u32 v240, v232, 3, v239
    v_lshl_add_u32 v239, v232, 4, v239
    s_cmp_lg_u32 s3, 0
    s_cbranch_scc1 L_gated__hw_19
    s_waitcnt vmcnt(20)
    v_cmp_eq_u32 vcc, s64, v255
    s_nop 1
    s_cmp_eq_u64 vcc, -1
    s_cbranch_scc1 L_gated__ck_21
    s_mov_b32 s69, 0
L_gated__pl_22:
    buffer_load_dword v255, v254, s[20:23], s79 offen sc1
    s_waitcnt vmcnt(0)
    v_cmp_eq_u32 vcc, s64, v255
    s_nop 1
    s_cmp_eq_u64 vcc, -1
    s_cbranch_scc1 L_gated__pd_23
    s_add_u32 s69, s69, 1
    s_cmp_lt_u32 s69, 0x40000
    s_cbranch_scc0 L_gated__pd_23
    s_sleep 2
    s_branch L_gated__pl_22
L_gated__pd_23:
L_gated__ck_21:
    v_mov_b32 v232, 161676
    v_mov_b32 v233, 1
    ds_write_b32 v232, v233
    s_branch L_gated__hd_20
L_gated__hw_19:
    v_mov_b32 v232, 161676
    s_mov_b32 s69, 0
L_gated__ls_24:
    ds_read_b32 v233, v232
    s_waitcnt lgkmcnt(0)
    v_readfirstlane_b32 s78, v233
    s_nop 1
    s_cmp_eq_u32 s78, 1
    s_cbranch_scc1 L_gated__ld_25
    s_add_u32 s69, s69, 1
    s_cmp_lt_u32 s69, 0x400000
    s_cbranch_scc0 L_gated__ld_25
    s_sleep 1
    s_branch L_gated__ls_24
L_gated__ld_25:
L_gated__hd_20:
    buffer_load_dwordx4 v[80:83], v224, s[20:23], s70 offen sc1
    buffer_load_dwordx4 v[84:87], v225, s[20:23], s70 offen sc1
    buffer_load_dwordx4 v[88:91], v226, s[20:23], s70 offen sc1
    buffer_load_dwordx4 v[92:95], v227, s[20:23], s70 offen sc1
    s_add_u32 s70, s70, 4096
    buffer_load_dwordx2 v[116:117], v246, s[20:23], s70 offen sc1
    buffer_load_dwordx2 v[118:119], v246, s[20:23], s70 offen offset:512 sc1
    buffer_load_dwordx2 v[120:121], v247, s[20:23], s70 offen sc1
    buffer_load_dwordx2 v[122:123], v247, s[20:23], s70 offen offset:512 sc1
    buffer_load_dwordx2 v[124:125], v248, s[20:23], s70 offen sc1
    buffer_load_dwordx2 v[126:127], v248, s[20:23], s70 offen offset:512 sc1
    buffer_load_dwordx2 v[128:129], v249, s[20:23], s70 offen sc1
    buffer_load_dwordx2 v[130:131], v249, s[20:23], s70 offen offset:512 sc1
    s_add_u32 s70, s70, 4096
    buffer_load_dwordx4 v[152:155], v224, s[20:23], s70 offen sc1
    buffer_load_dwordx4 v[156:159], v225, s[20:23], s70 offen sc1
    buffer_load_dwordx4 v[160:163], v226, s[20:23], s70 offen sc1
    buffer_load_dwordx4 v[164:167], v227, s[20:23], s70 offen sc1
    s_add_u32 s70, s70, 4096
    buffer_load_dwordx4 v[188:191], v224, s[20:23], s70 offen sc1
    buffer_load_dwordx4 v[192:195], v225, s[20:23], s70 offen sc1
    buffer_load_dwordx4 v[196:199], v226, s[20:23], s70 offen sc1
    buffer_load_dwordx4 v[200:203], v227, s[20:23], s70 offen sc1
    s_add_u32 s70, s70, 4096
    s_waitcnt vmcnt(16)
    v_mfma_f32_16x16x32_bf16 v[0:3], v[96:99], v[80:83], 0
    v_mfma_f32_16x16x32_bf16 v[16:19], v[100:103], v[80:83], 0
    v_mfma_f32_16x16x32_bf16 v[32:35], v[104:107], v[80:83], 0
    v_mfma_f32_16x16x32_bf16 v[48:51], v[108:111], v[80:83], 0
    v_mfma_f32_16x16x32_bf16 v[64:67], v[112:115], v[80:83], 0
    buffer_load_dwordx2 v[80:81], v246, s[20:23], s70 offen sc1
    buffer_load_dwordx2 v[82:83], v246, s[20:23], s70 offen offset:512 sc1
    v_mfma_f32_16x16x32_bf16 v[4:7], v[96:99], v[84:87], 0
    v_mfma_f32_16x16x32_bf16 v[20:23], v[100:103], v[84:87], 0
    v_mfma_f32_16x16x32_bf16 v[36:39], v[104:107], v[84:87], 0
    v_mfma_f32_16x16x32_bf16 v[52:55], v[108:111], v[84:87], 0
    v_mfma_f32_16x16x32_bf16 v[68:71], v[112:115], v[84:87], 0
    buffer_load_dwordx2 v[84:85], v247, s[20:23], s70 offen sc1
    buffer_load_dwordx2 v[86:87], v247, s[20:23], s70 offen offset:512 sc1
    v_mfma_f32_16x16x32_bf16 v[8:11], v[96:99], v[88:91], 0
    v_mfma_f32_16x16x32_bf16 v[24:27], v[100:103], v[88:91], 0
    v_mfma_f32_16x16x32_bf16 v[40:43], v[104:107], v[88:91], 0
    v_mfma_f32_16x16x32_bf16 v[56:59], v[108:111], v[88:91], 0
    v_mfma_f32_16x16x32_bf16 v[72:75], v[112:115], v[88:91], 0
    buffer_load_dwordx2 v[88:89], v248, s[20:23], s70 offen sc1
    buffer_load_dwordx2 v[90:91], v248, s[20:23], s70 offen offset:512 sc1
    v_mfma_f32_16x16x32_bf16 v[12:15], v[96:99], v[92:95], 0
    v_mfma_f32_16x16x32_bf16 v[28:31], v[100:103], v[92:95], 0
    v_mfma_f32_16x16x32_bf16 v[44:47], v[104:107], v[92:95], 0
    v_mfma_f32_16x16x32_bf16 v[60:63], v[108:111], v[92:95], 0
    v_mfma_f32_16x16x32_bf16 v[76:79], v[112:115], v[92:95], 0
    buffer_load_dwordx2 v[92:93], v249, s[20:23], s70 offen sc1
    buffer_load_dwordx2 v[94:95], v249, s[20:23], s70 offen offset:512 sc1
    s_add_u32 s70, s70, 4096
    s_waitcnt vmcnt(16)
    v_mfma_f32_16x16x32_bf16 v[0:3], v[132:135], v[116:119], v[0:3]
    v_mfma_f32_16x16x32_bf16 v[16:19], v[136:139], v[116:119], v[16:19]
    v_add_u32 v241, s73, v245
    v_add_u32 v244, s73, v253
    v_mfma_f32_16x16x32_bf16 v[32:35], v[140:143], v[116:119], v[32:35]
    v_mfma_f32_16x16x32_bf16 v[48:51], v[144:147], v[116:119], v[48:51]
    ds_read_b64_tr_b16 v[96:97], v241 offset:0
    v_mfma_f32_16x16x32_bf16 v[64:67], v[148:151], v[116:119], v[64:67]
    buffer_load_dwordx4 v[116:119], v224, s[20:23], s70 offen sc1
    v_mfma_f32_16x16x32_bf16 v[4:7], v[132:135], v[120:123], v[4:7]
    v_mfma_f32_16x16x32_bf16 v[20:23], v[136:139], v[120:123], v[20:23]
    ds_read_b64_tr_b16 v[98:99], v241 offset:2560
    v_mfma_f32_16x16x32_bf16 v[36:39], v[140:143], v[120:123], v[36:39]
    v_mfma_f32_16x16x32_bf16 v[52:55], v[144:147], v[120:123], v[52:55]
    ds_read_b64_tr_b16 v[100:101], v241 offset:8
    v_mfma_f32_16x16x32_bf16 v[68:71], v[148:151], v[120:123], v[68:71]
    buffer_load_dwordx4 v[120:123], v225, s[20:23], s70 offen sc1
    v_mfma_f32_16x16x32_bf16 v[8:11], v[132:135], v[124:127], v[8:11]
    v_mfma_f32_16x16x32_bf16 v[24:27], v[136:139], v[124:127], v[24:27]
    ds_read_b64_tr_b16 v[102:103], v241 offset:2568
    v_mfma_f32_16x16x32_bf16 v[40:43], v[140:143], v[124:127], v[40:43]
    v_mfma_f32_16x16x32_bf16 v[56:59], v[144:147], v[124:127], v[56:59]
    ds_read_b64_tr_b16 v[104:105], v241 offset:64
    v_mfma_f32_16x16x32_bf16 v[72:75], v[148:151], v[124:127], v[72:75]
    buffer_load_dwordx4 v[124:127], v226, s[20:23], s70 offen sc1
    v_mfma_f32_16x16x32_bf16 v[12:15], v[132:135], v[128:131], v[12:15]
    v_mfma_f32_16x16x32_bf16 v[28:31], v[136:139], v[128:131], v[28:31]
    ds_read_b64_tr_b16 v[106:107], v241 offset:2624
    v_mfma_f32_16x16x32_bf16 v[44:47], v[140:143], v[128:131], v[44:47]
    v_mfma_f32_16x16x32_bf16 v[60:63], v[144:147], v[128:131], v[60:63]
    ds_read_b64_tr_b16 v[108:109], v241 offset:72
    v_mfma_f32_16x16x32_bf16 v[76:79], v[148:151], v[128:131], v[76:79]
    buffer_load_dwordx4 v[128:131], v227, s[20:23], s70 offen sc1
    s_add_u32 s70, s70, 4096
    ds_read_b64_tr_b16 v[110:111], v241 offset:2632
    ds_read_b64_tr_b16 v[112:113], v244 offset:128
    ds_read_b64_tr_b16 v[114:115], v244 offset:2688
    s_waitcnt vmcnt(16)
    v_mfma_f32_16x16x32_bf16 v[0:3], v[168:171], v[152:155], v[0:3]
    v_mfma_f32_16x16x32_bf16 v[16:19], v[172:175], v[152:155], v[16:19]
    v_add_u32 v241, s74, v245
    v_add_u32 v244, s74, v253
    v_mfma_f32_16x16x32_bf16 v[32:35], v[176:179], v[152:155], v[32:35]
    v_mfma_f32_16x16x32_bf16 v[48:51], v[180:183], v[152:155], v[48:51]
    ds_read_b64_tr_b16 v[132:133], v241 offset:0
    v_mfma_f32_16x16x32_bf16 v[64:67], v[184:187], v[152:155], v[64:67]
    buffer_load_dwordx4 v[152:155], v224, s[20:23], s70 offen sc1
    v_mfma_f32_16x16x32_bf16 v[4:7], v[168:171], v[156:159], v[4:7]
    v_mfma_f32_16x16x32_bf16 v[20:23], v[172:175], v[156:159], v[20:23]
    ds_read_b64_tr_b16 v[134:135], v241 offset:2560
    v_mfma_f32_16x16x32_bf16 v[36:39], v[176:179], v[156:159], v[36:39]
    v_mfma_f32_16x16x32_bf16 v[52:55], v[180:183], v[156:159], v[52:55]
    ds_read_b64_tr_b16 v[136:137], v241 offset:8
    v_mfma_f32_16x16x32_bf16 v[68:71], v[184:187], v[156:159], v[68:71]
    buffer_load_dwordx4 v[156:159], v225, s[20:23], s70 offen sc1
    v_mfma_f32_16x16x32_bf16 v[8:11], v[168:171], v[160:163], v[8:11]
    v_mfma_f32_16x16x32_bf16 v[24:27], v[172:175], v[160:163], v[24:27]
    ds_read_b64_tr_b16 v[138:139], v241 offset:2568
    v_mfma_f32_16x16x32_bf16 v[40:43], v[176:179], v[160:163], v[40:43]
    v_mfma_f32_16x16x32_bf16 v[56:59], v[180:183], v[160:163], v[56:59]
    ds_read_b64_tr_b16 v[140:141], v241 offset:64
    v_mfma_f32_16x16x32_bf16 v[72:75], v[184:187], v[160:163], v[72:75]
    buffer_load_dwordx4 v[160:163], v226, s[20:23], s70 offen sc1
    v_mfma_f32_16x16x32_bf16 v[12:15], v[168:171], v[164:167], v[12:15]
    v_mfma_f32_16x16x32_bf16 v[28:31], v[172:175], v[164:167], v[28:31]
    ds_read_b64_tr_b16 v[142:143], v241 offset:2624
    v_mfma_f32_16x16x32_bf16 v[44:47], v[176:179], v[164:167], v[44:47]
    v_mfma_f32_16x16x32_bf16 v[60:63], v[180:183], v[164:167], v[60:63]
    ds_read_b64_tr_b16 v[144:145], v241 offset:72
    v_mfma_f32_16x16x32_bf16 v[76:79], v[184:187], v[164:167], v[76:79]
    buffer_load_dwordx4 v[164:167], v227, s[20:23], s70 offen sc1
    s_add_u32 s70, s70, 4096
    ds_read_b64_tr_b16 v[146:147], v241 offset:2632
    ds_read_b64_tr_b16 v[148:149], v244 offset:128
    ds_read_b64_tr_b16 v[150:151], v244 offset:2688
    s_waitcnt vmcnt(16)
    v_mfma_f32_16x16x32_bf16 v[0:3], v[204:207], v[188:191], v[0:3]
    v_mfma_f32_16x16x32_bf16 v[16:19], v[208:211], v[188:191], v[16:19]
    v_add_u32 v241, s75, v245
    v_add_u32 v244, s75, v253
    v_mfma_f32_16x16x32_bf16 v[32:35], v[212:215], v[188:191], v[32:35]
    v_mfma_f32_16x16x32_bf16 v[48:51], v[216:219], v[188:191], v[48:51]
    ds_read_b64_tr_b16 v[168:169], v241 offset:0
    v_mfma_f32_16x16x32_bf16 v[64:67], v[220:223], v[188:191], v[64:67]
    buffer_load_dwordx2 v[188:189], v246, s[20:23], s70 offen sc1
    buffer_load_dwordx2 v[190:191], v246, s[20:23], s70 offen offset:512 sc1
    v_mfma_f32_16x16x32_bf16 v[4:7], v[204:207], v[192:195], v[4:7]
    v_mfma_f32_16x16x32_bf16 v[20:23], v[208:211], v[192:195], v[20:23]
    ds_read_b64_tr_b16 v[170:171], v241 offset:2560
    v_mfma_f32_16x16x32_bf16 v[36:39], v[212:215], v[192:195], v[36:39]
    v_mfma_f32_16x16x32_bf16 v[52:55], v[216:219], v[192:195], v[52:55]
    ds_read_b64_tr_b16 v[172:173], v241 offset:8
    v_mfma_f32_16x16x32_bf16 v[68:71], v[220:223], v[192:195], v[68:71]
    buffer_load_dwordx2 v[192:193], v247, s[20:23], s70 offen sc1
    buffer_load_dwordx2 v[194:195], v247, s[20:23], s70 offen offset:512 sc1
    v_mfma_f32_16x16x32_bf16 v[8:11], v[204:207], v[196:199], v[8:11]
    v_mfma_f32_16x16x32_bf16 v[24:27], v[208:211], v[196:199], v[24:27]
    ds_read_b64_tr_b16 v[174:175], v241 offset:2568
    v_mfma_f32_16x16x32_bf16 v[40:43], v[212:215], v[196:199], v[40:43]
    v_mfma_f32_16x16x32_bf16 v[56:59], v[216:219], v[196:199], v[56:59]
    ds_read_b64_tr_b16 v[176:177], v241 offset:64
    v_mfma_f32_16x16x32_bf16 v[72:75], v[220:223], v[196:199], v[72:75]
    buffer_load_dwordx2 v[196:197], v248, s[20:23], s70 offen sc1
    buffer_load_dwordx2 v[198:199], v248, s[20:23], s70 offen offset:512 sc1
    v_mfma_f32_16x16x32_bf16 v[12:15], v[204:207], v[200:203], v[12:15]
    v_mfma_f32_16x16x32_bf16 v[28:31], v[208:211], v[200:203], v[28:31]
    ds_read_b64_tr_b16 v[178:179], v241 offset:2624
    v_mfma_f32_16x16x32_bf16 v[44:47], v[212:215], v[200:203], v[44:47]
    v_mfma_f32_16x16x32_bf16 v[60:63], v[216:219], v[200:203], v[60:63]
    ds_read_b64_tr_b16 v[180:181], v241 offset:72
    v_mfma_f32_16x16x32_bf16 v[76:79], v[220:223], v[200:203], v[76:79]
    buffer_load_dwordx2 v[200:201], v249, s[20:23], s70 offen sc1
    buffer_load_dwordx2 v[202:203], v249, s[20:23], s70 offen offset:512 sc1
    s_add_u32 s70, s70, 4096
    ds_read_b64_tr_b16 v[182:183], v241 offset:2632
    ds_read_b64_tr_b16 v[184:185], v244 offset:128
    ds_read_b64_tr_b16 v[186:187], v244 offset:2688
    s_waitcnt vmcnt(16) lgkmcnt(0)
    v_mfma_f32_16x16x32_bf16 v[0:3], v[96:99], v[80:83], v[0:3]
    v_mfma_f32_16x16x32_bf16 v[16:19], v[100:103], v[80:83], v[16:19]
    buffer_load_dwordx4 v[204:207], v228, s[20:23], s71 offen offset:0 sc1
    v_mfma_f32_16x16x32_bf16 v[32:35], v[104:107], v[80:83], v[32:35]
    v_mfma_f32_16x16x32_bf16 v[48:51], v[108:111], v[80:83], v[48:51]
    buffer_load_dwordx4 v[208:211], v228, s[20:23], s71 offen offset:1024 sc1
    v_mfma_f32_16x16x32_bf16 v[64:67], v[112:115], v[80:83], v[64:67]
    buffer_load_dwordx4 v[80:83], v224, s[20:23], s70 offen sc1
    v_mfma_f32_16x16x32_bf16 v[4:7], v[96:99], v[84:87], v[4:7]
    v_mfma_f32_16x16x32_bf16 v[20:23], v[100:103], v[84:87], v[20:23]
    buffer_load_dwordx4 v[212:215], v228, s[20:23], s71 offen offset:2048 sc1
    v_mfma_f32_16x16x32_bf16 v[36:39], v[104:107], v[84:87], v[36:39]
    v_mfma_f32_16x16x32_bf16 v[52:55], v[108:111], v[84:87], v[52:55]
    buffer_load_dwordx4 v[216:219], v228, s[20:23], s71 offen offset:3072 sc1
    v_mfma_f32_16x16x32_bf16 v[68:71], v[112:115], v[84:87], v[68:71]
    buffer_load_dwordx4 v[84:87], v225, s[20:23], s70 offen sc1
    v_mfma_f32_16x16x32_bf16 v[8:11], v[96:99], v[88:91], v[8:11]
    v_mfma_f32_16x16x32_bf16 v[24:27], v[100:103], v[88:91], v[24:27]
    buffer_load_dwordx4 v[220:223], v228, s[20:23], s72 offen sc1
    s_add_u32 s71, s71, 5120
    s_add_u32 s72, s72, 5120
    v_mfma_f32_16x16x32_bf16 v[40:43], v[104:107], v[88:91], v[40:43]
    v_mfma_f32_16x16x32_bf16 v[56:59], v[108:111], v[88:91], v[56:59]
    v_mfma_f32_16x16x32_bf16 v[72:75], v[112:115], v[88:91], v[72:75]
    buffer_load_dwordx4 v[88:91], v226, s[20:23], s70 offen sc1
    v_mfma_f32_16x16x32_bf16 v[12:15], v[96:99], v[92:95], v[12:15]
    v_mfma_f32_16x16x32_bf16 v[28:31], v[100:103], v[92:95], v[28:31]
    v_mfma_f32_16x16x32_bf16 v[44:47], v[104:107], v[92:95], v[44:47]
    v_mfma_f32_16x16x32_bf16 v[60:63], v[108:111], v[92:95], v[60:63]
    v_mfma_f32_16x16x32_bf16 v[76:79], v[112:115], v[92:95], v[76:79]
    buffer_load_dwordx4 v[92:95], v227, s[20:23], s70 offen sc1
    s_add_u32 s70, s70, 4096
    s_waitcnt vmcnt(21) lgkmcnt(0)
    v_mfma_f32_16x16x32_bf16 v[0:3], v[132:135], v[116:119], v[0:3]
    v_mfma_f32_16x16x32_bf16 v[16:19], v[136:139], v[116:119], v[16:19]
    buffer_load_dwordx4 v[96:99], v228, s[20:23], s71 offen offset:0 sc1
    v_mfma_f32_16x16x32_bf16 v[32:35], v[140:143], v[116:119], v[32:35]
    v_mfma_f32_16x16x32_bf16 v[48:51], v[144:147], v[116:119], v[48:51]
    buffer_load_dwordx4 v[100:103], v228, s[20:23], s71 offen offset:1024 sc1
    v_mfma_f32_16x16x32_bf16 v[64:67], v[148:151], v[116:119], v[64:67]
    buffer_load_dwordx4 v[116:119], v224, s[20:23], s70 offen sc1
    v_mfma_f32_16x16x32_bf16 v[4:7], v[132:135], v[120:123], v[4:7]
    v_mfma_f32_16x16x32_bf16 v[20:23], v[136:139], v[120:123], v[20:23]
    buffer_load_dwordx4 v[104:107], v228, s[20:23], s71 offen offset:2048 sc1
    v_mfma_f32_16x16x32_bf16 v[36:39], v[140:143], v[120:123], v[36:39]
    v_mfma_f32_16x16x32_bf16 v[52:55], v[144:147], v[120:123], v[52:55]
    buffer_load_dwordx4 v[108:111], v228, s[20:23], s71 offen offset:3072 sc1
    v_mfma_f32_16x16x32_bf16 v[68:71], v[148:151], v[120:123], v[68:71]
    buffer_load_dwordx4 v[120:123], v225, s[20:23], s70 offen sc1
    v_mfma_f32_16x16x32_bf16 v[8:11], v[132:135], v[124:127], v[8:11]
    v_mfma_f32_16x16x32_bf16 v[24:27], v[136:139], v[124:127], v[24:27]
    buffer_load_dwordx4 v[112:115], v228, s[20:23], s72 offen sc1
    s_add_u32 s71, s71, 5120
    s_add_u32 s72, s72, 5120
    v_mfma_f32_16x16x32_bf16 v[40:43], v[140:143], v[124:127], v[40:43]
    v_mfma_f32_16x16x32_bf16 v[56:59], v[144:147], v[124:127], v[56:59]
    v_mfma_f32_16x16x32_bf16 v[72:75], v[148:151], v[124:127], v[72:75]
    buffer_load_dwordx4 v[124:127], v226, s[20:23], s70 offen sc1
    v_mfma_f32_16x16x32_bf16 v[12:15], v[132:135], v[128:131], v[12:15]
    v_mfma_f32_16x16x32_bf16 v[28:31], v[136:139], v[128:131], v[28:31]
    v_mfma_f32_16x16x32_bf16 v[44:47], v[140:143], v[128:131], v[44:47]
    v_mfma_f32_16x16x32_bf16 v[60:63], v[144:147], v[128:131], v[60:63]
    v_mfma_f32_16x16x32_bf16 v[76:79], v[148:151], v[128:131], v[76:79]
    buffer_load_dwordx4 v[128:131], v227, s[20:23], s70 offen sc1
    s_add_u32 s70, s70, 4096
    s_waitcnt vmcnt(26) lgkmcnt(0)
    v_mfma_f32_16x16x32_bf16 v[0:3], v[168:171], v[152:155], v[0:3]
    v_mfma_f32_16x16x32_bf16 v[16:19], v[172:175], v[152:155], v[16:19]
    buffer_load_dwordx4 v[132:135], v228, s[20:23], s71 offen offset:0 sc1
    v_mfma_f32_16x16x32_bf16 v[32:35], v[176:179], v[152:155], v[32:35]
    v_mfma_f32_16x16x32_bf16 v[48:51], v[180:183], v[152:155], v[48:51]
    buffer_load_dwordx4 v[136:139], v228, s[20:23], s71 offen offset:1024 sc1
    v_mfma_f32_16x16x32_bf16 v[64:67], v[184:187], v[152:155], v[64:67]
    buffer_load_dwordx2 v[152:153], v246, s[20:23], s70 offen sc1
    buffer_load_dwordx2 v[154:155], v246, s[20:23], s70 offen offset:512 sc1
    v_mfma_f32_16x16x32_bf16 v[4:7], v[168:171], v[156:159], v[4:7]
    v_mfma_f32_16x16x32_bf16 v[20:23], v[172:175], v[156:159], v[20:23]
    buffer_load_dwordx4 v[140:143], v228, s[20:23], s71 offen offset:2048 sc1
    v_mfma_f32_16x16x32_bf16 v[36:39], v[176:179], v[156:159], v[36:39]
    v_mfma_f32_16x16x32_bf16 v[52:55], v[180:183], v[156:159], v[52:55]
    buffer_load_dwordx4 v[144:147], v228, s[20:23], s71 offen offset:3072 sc1
    v_mfma_f32_16x16x32_bf16 v[68:71], v[184:187], v[156:159], v[68:71]
    buffer_load_dwordx2 v[156:157], v247, s[20:23], s70 offen sc1
    buffer_load_dwordx2 v[158:159], v247, s[20:23], s70 offen offset:512 sc1
    v_mfma_f32_16x16x32_bf16 v[8:11], v[168:171], v[160:163], v[8:11]
    v_mfma_f32_16x16x32_bf16 v[24:27], v[172:175], v[160:163], v[24:27]
    buffer_load_dwordx4 v[148:151], v228, s[20:23], s72 offen sc1
    s_add_u32 s71, s71, 5120
    s_add_u32 s72, s72, 5120
    v_mfma_f32_16x16x32_bf16 v[40:43], v[176:179], v[160:163], v[40:43]
    v_mfma_f32_16x16x32_bf16 v[56:59], v[180:183], v[160:163], v[56:59]
    v_mfma_f32_16x16x32_bf16 v[72:75], v[184:187], v[160:163], v[72:75]
    buffer_load_dwordx2 v[160:161], v248, s[20:23], s70 offen sc1
    buffer_load_dwordx2 v[162:163], v248, s[20:23], s70 offen offset:512 sc1
    v_mfma_f32_16x16x32_bf16 v[12:15], v[168:171], v[164:167], v[12:15]
    v_mfma_f32_16x16x32_bf16 v[28:31], v[172:175], v[164:167], v[28:31]
    v_mfma_f32_16x16x32_bf16 v[44:47], v[176:179], v[164:167], v[44:47]
    v_mfma_f32_16x16x32_bf16 v[60:63], v[180:183], v[164:167], v[60:63]
    v_mfma_f32_16x16x32_bf16 v[76:79], v[184:187], v[164:167], v[76:79]
    buffer_load_dwordx2 v[164:165], v249, s[20:23], s70 offen sc1
    buffer_load_dwordx2 v[166:167], v249, s[20:23], s70 offen offset:512 sc1
    s_add_u32 s70, s70, 4096
    v_mov_b32 v232, 161688
    v_mov_b32 v233, 1
    s_mov_b64 exec, 1
    ds_add_u32 v232, v233
    s_mov_b64 exec, -1
    s_waitcnt vmcnt(24)
    v_mfma_f32_16x16x32_bf16 v[0:3], v[204:207], v[188:191], v[0:3]
    v_mfma_f32_16x16x32_bf16 v[16:19], v[208:211], v[188:191], v[16:19]
    buffer_load_dwordx4 v[168:171], v228, s[20:23], s71 offen offset:0 sc1
    v_mfma_f32_16x16x32_bf16 v[32:35], v[212:215], v[188:191], v[32:35]
    v_mfma_f32_16x16x32_bf16 v[48:51], v[216:219], v[188:191], v[48:51]
    buffer_load_dwordx4 v[172:175], v228, s[20:23], s71 offen offset:1024 sc1
    v_mfma_f32_16x16x32_bf16 v[64:67], v[220:223], v[188:191], v[64:67]
    buffer_load_dwordx4 v[188:191], v224, s[20:23], s70 offen sc1
    v_mfma_f32_16x16x32_bf16 v[4:7], v[204:207], v[192:195], v[4:7]
    v_mfma_f32_16x16x32_bf16 v[20:23], v[208:211], v[192:195], v[20:23]
    buffer_load_dwordx4 v[176:179], v228, s[20:23], s71 offen offset:2048 sc1
    v_mfma_f32_16x16x32_bf16 v[36:39], v[212:215], v[192:195], v[36:39]
    v_mfma_f32_16x16x32_bf16 v[52:55], v[216:219], v[192:195], v[52:55]
    buffer_load_dwordx4 v[180:183], v228, s[20:23], s71 offen offset:3072 sc1
    v_mfma_f32_16x16x32_bf16 v[68:71], v[220:223], v[192:195], v[68:71]
    buffer_load_dwordx4 v[192:195], v225, s[20:23], s70 offen sc1
    v_mfma_f32_16x16x32_bf16 v[8:11], v[204:207], v[196:199], v[8:11]
    v_mfma_f32_16x16x32_bf16 v[24:27], v[208:211], v[196:199], v[24:27]
    buffer_load_dwordx4 v[184:187], v228, s[20:23], s72 offen sc1
    s_add_u32 s71, s71, 5120
    s_add_u32 s72, s72, 5120
    v_mfma_f32_16x16x32_bf16 v[40:43], v[212:215], v[196:199], v[40:43]
    v_mfma_f32_16x16x32_bf16 v[56:59], v[216:219], v[196:199], v[56:59]
    v_mfma_f32_16x16x32_bf16 v[72:75], v[220:223], v[196:199], v[72:75]
    buffer_load_dwordx4 v[196:199], v226, s[20:23], s70 offen sc1
    v_mfma_f32_16x16x32_bf16 v[12:15], v[204:207], v[200:203], v[12:15]
    v_mfma_f32_16x16x32_bf16 v[28:31], v[208:211], v[200:203], v[28:31]
    v_mfma_f32_16x16x32_bf16 v[44:47], v[212:215], v[200:203], v[44:47]
    v_mfma_f32_16x16x32_bf16 v[60:63], v[216:219], v[200:203], v[60:63]
    v_mfma_f32_16x16x32_bf16 v[76:79], v[220:223], v[200:203], v[76:79]
    buffer_load_dwordx4 v[200:203], v227, s[20:23], s70 offen sc1
    s_add_u32 s70, s70, 4096
    s_waitcnt vmcnt(24)
    v_mfma_f32_16x16x32_bf16 v[0:3], v[96:99], v[80:83], v[0:3]
    v_mfma_f32_16x16x32_bf16 v[16:19], v[100:103], v[80:83], v[16:19]
    buffer_load_dwordx4 v[204:207], v228, s[20:23], s71 offen offset:0 sc1
    v_mfma_f32_16x16x32_bf16 v[32:35], v[104:107], v[80:83], v[32:35]
    v_mfma_f32_16x16x32_bf16 v[48:51], v[108:111], v[80:83], v[48:51]
    buffer_load_dwordx4 v[208:211], v228, s[20:23], s71 offen offset:1024 sc1
    v_mfma_f32_16x16x32_bf16 v[64:67], v[112:115], v[80:83], v[64:67]
    v_mfma_f32_16x16x32_bf16 v[4:7], v[96:99], v[84:87], v[4:7]
    v_mfma_f32_16x16x32_bf16 v[20:23], v[100:103], v[84:87], v[20:23]
    buffer_load_dwordx4 v[212:215], v228, s[20:23], s71 offen offset:2048 sc1
    v_mfma_f32_16x16x32_bf16 v[36:39], v[104:107], v[84:87], v[36:39]
    v_mfma_f32_16x16x32_bf16 v[52:55], v[108:111], v[84:87], v[52:55]
    buffer_load_dwordx4 v[216:219], v228, s[20:23], s71 offen offset:3072 sc1
    v_mfma_f32_16x16x32_bf16 v[68:71], v[112:115], v[84:87], v[68:71]
    v_mfma_f32_16x16x32_bf16 v[8:11], v[96:99], v[88:91], v[8:11]
    v_mfma_f32_16x16x32_bf16 v[24:27], v[100:103], v[88:91], v[24:27]
    buffer_load_dwordx4 v[220:223], v228, s[20:23], s72 offen sc1
    s_add_u32 s71, s71, 5120
    s_add_u32 s72, s72, 5120
    v_mfma_f32_16x16x32_bf16 v[40:43], v[104:107], v[88:91], v[40:43]
    v_mfma_f32_16x16x32_bf16 v[56:59], v[108:111], v[88:91], v[56:59]
    v_mfma_f32_16x16x32_bf16 v[72:75], v[112:115], v[88:91], v[72:75]
    v_mfma_f32_16x16x32_bf16 v[12:15], v[96:99], v[92:95], v[12:15]
    v_mfma_f32_16x16x32_bf16 v[28:31], v[100:103], v[92:95], v[28:31]
    v_mfma_f32_16x16x32_bf16 v[44:47], v[104:107], v[92:95], v[44:47]
    v_mfma_f32_16x16x32_bf16 v[60:63], v[108:111], v[92:95], v[60:63]
    v_mfma_f32_16x16x32_bf16 v[76:79], v[112:115], v[92:95], v[76:79]
    s_waitcnt vmcnt(18)
    v_mfma_f32_16x16x32_bf16 v[0:3], v[132:135], v[116:119], v[0:3]
    v_mfma_f32_16x16x32_bf16 v[16:19], v[136:139], v[116:119], v[16:19]
    v_mfma_f32_16x16x32_bf16 v[32:35], v[140:143], v[116:119], v[32:35]
    v_mfma_f32_16x16x32_bf16 v[48:51], v[144:147], v[116:119], v[48:51]
    v_mfma_f32_16x16x32_bf16 v[64:67], v[148:151], v[116:119], v[64:67]
    v_mfma_f32_16x16x32_bf16 v[4:7], v[132:135], v[120:123], v[4:7]
    v_mfma_f32_16x16x32_bf16 v[20:23], v[136:139], v[120:123], v[20:23]
    v_mfma_f32_16x16x32_bf16 v[36:39], v[140:143], v[120:123], v[36:39]
    v_mfma_f32_16x16x32_bf16 v[52:55], v[144:147], v[120:123], v[52:55]
    v_mfma_f32_16x16x32_bf16 v[68:71], v[148:151], v[120:123], v[68:71]
    v_mfma_f32_16x16x32_bf16 v[8:11], v[132:135], v[124:127], v[8:11]
    v_mfma_f32_16x16x32_bf16 v[24:27], v[136:139], v[124:127], v[24:27]
    v_mfma_f32_16x16x32_bf16 v[40:43], v[140:143], v[124:127], v[40:43]
    v_mfma_f32_16x16x32_bf16 v[56:59], v[144:147], v[124:127], v[56:59]
    v_mfma_f32_16x16x32_bf16 v[72:75], v[148:151], v[124:127], v[72:75]
    v_mfma_f32_16x16x32_bf16 v[12:15], v[132:135], v[128:131], v[12:15]
    v_mfma_f32_16x16x32_bf16 v[28:31], v[136:139], v[128:131], v[28:31]
    v_mfma_f32_16x16x32_bf16 v[44:47], v[140:143], v[128:131], v[44:47]
    v_mfma_f32_16x16x32_bf16 v[60:63], v[144:147], v[128:131], v[60:63]
    v_mfma_f32_16x16x32_bf16 v[76:79], v[148:151], v[128:131], v[76:79]
    s_waitcnt vmcnt(7)
    v_mfma_f32_16x16x32_bf16 v[0:3], v[168:171], v[152:155], v[0:3]
    v_mfma_f32_16x16x32_bf16 v[16:19], v[172:175], v[152:155], v[16:19]
    v_mfma_f32_16x16x32_bf16 v[32:35], v[176:179], v[152:155], v[32:35]
    v_mfma_f32_16x16x32_bf16 v[48:51], v[180:183], v[152:155], v[48:51]
    v_mfma_f32_16x16x32_bf16 v[64:67], v[184:187], v[152:155], v[64:67]
    v_mfma_f32_16x16x32_bf16 v[4:7], v[168:171], v[156:159], v[4:7]
    v_mfma_f32_16x16x32_bf16 v[20:23], v[172:175], v[156:159], v[20:23]
    v_mfma_f32_16x16x32_bf16 v[36:39], v[176:179], v[156:159], v[36:39]
    v_mfma_f32_16x16x32_bf16 v[52:55], v[180:183], v[156:159], v[52:55]
    v_mfma_f32_16x16x32_bf16 v[68:71], v[184:187], v[156:159], v[68:71]
    v_mfma_f32_16x16x32_bf16 v[8:11], v[168:171], v[160:163], v[8:11]
    v_mfma_f32_16x16x32_bf16 v[24:27], v[172:175], v[160:163], v[24:27]
    v_mfma_f32_16x16x32_bf16 v[40:43], v[176:179], v[160:163], v[40:43]
    v_mfma_f32_16x16x32_bf16 v[56:59], v[180:183], v[160:163], v[56:59]
    v_mfma_f32_16x16x32_bf16 v[72:75], v[184:187], v[160:163], v[72:75]
    v_mfma_f32_16x16x32_bf16 v[12:15], v[168:171], v[164:167], v[12:15]
    v_mfma_f32_16x16x32_bf16 v[28:31], v[172:175], v[164:167], v[28:31]
    v_mfma_f32_16x16x32_bf16 v[44:47], v[176:179], v[164:167], v[44:47]
    v_mfma_f32_16x16x32_bf16 v[60:63], v[180:183], v[164:167], v[60:63]
    v_mfma_f32_16x16x32_bf16 v[76:79], v[184:187], v[164:167], v[76:79]
    s_waitcnt vmcnt(0)
    v_mfma_f32_16x16x32_bf16 v[4:7], v[204:207], v[192:195], v[4:7]
    v_mfma_f32_16x16x32_bf16 v[20:23], v[208:211], v[192:195], v[20:23]
    v_mfma_f32_16x16x32_bf16 v[36:39], v[212:215], v[192:195], v[36:39]
    v_mfma_f32_16x16x32_bf16 v[52:55], v[216:219], v[192:195], v[52:55]
    v_mfma_f32_16x16x32_bf16 v[68:71], v[220:223], v[192:195], v[68:71]
    v_mfma_f32_16x16x32_bf16 v[8:11], v[204:207], v[196:199], v[8:11]
    v_mfma_f32_16x16x32_bf16 v[24:27], v[208:211], v[196:199], v[24:27]
    v_mfma_f32_16x16x32_bf16 v[40:43], v[212:215], v[196:199], v[40:43]
    v_mfma_f32_16x16x32_bf16 v[56:59], v[216:219], v[196:199], v[56:59]
    v_mfma_f32_16x16x32_bf16 v[72:75], v[220:223], v[196:199], v[72:75]
    v_mfma_f32_16x16x32_bf16 v[12:15], v[204:207], v[200:203], v[12:15]
    ds_write_b128 v250, v[4:7] offset:0
    v_mfma_f32_16x16x32_bf16 v[28:31], v[208:211], v[200:203], v[28:31]
    ds_write_b128 v250, v[20:23] offset:1024
    v_mfma_f32_16x16x32_bf16 v[44:47], v[212:215], v[200:203], v[44:47]
    ds_write_b128 v250, v[36:39] offset:2048
    v_mfma_f32_16x16x32_bf16 v[60:63], v[216:219], v[200:203], v[60:63]
    ds_write_b128 v250, v[52:55] offset:3072
    v_mfma_f32_16x16x32_bf16 v[76:79], v[220:223], v[200:203], v[76:79]
    ds_write_b128 v250, v[68:71] offset:4096
    v_mfma_f32_16x16x32_bf16 v[0:3], v[204:207], v[188:191], v[0:3]
    ds_write_b128 v251, v[8:11] offset:0
    v_mfma_f32_16x16x32_bf16 v[16:19], v[208:211], v[188:191], v[16:19]
    ds_write_b128 v251, v[24:27] offset:1024
    v_mfma_f32_16x16x32_bf16 v[32:35], v[212:215], v[188:191], v[32:35]
    ds_write_b128 v251, v[40:43] offset:2048
    v_mfma_f32_16x16x32_bf16 v[48:51], v[216:219], v[188:191], v[48:51]
    ds_write_b128 v251, v[56:59] offset:3072
    v_mfma_f32_16x16x32_bf16 v[64:67], v[220:223], v[188:191], v[64:67]
    ds_write_b128 v251, v[72:75] offset:4096
    ds_write_b128 v252, v[12:15] offset:0
    ds_write_b128 v252, v[28:31] offset:1024
    ds_write_b128 v252, v[44:47] offset:2048
    ds_write_b128 v252, v[60:63] offset:3072
    ds_write_b128 v252, v[76:79] offset:4096
    s_waitcnt lgkmcnt(0)
    s_barrier
    ds_read_b128 v[80:83], v231 offset:0
    ds_read_b128 v[84:87], v231 offset:1024
    ds_read_b128 v[88:91], v231 offset:2048
    ds_read_b128 v[92:95], v231 offset:3072
    ds_read_b128 v[96:99], v231 offset:4096
    ds_read_b128 v[100:103], v231 offset:5120
    ds_read_b128 v[104:107], v231 offset:6144
    ds_read_b128 v[108:111], v231 offset:7168
    ds_read_b128 v[112:115], v231 offset:8192
    ds_read_b128 v[116:119], v231 offset:9216
    ds_read_b128 v[120:123], v231 offset:10240
    ds_read_b128 v[124:127], v231 offset:11264
    ds_read_b128 v[128:131], v231 offset:12288
    ds_read_b128 v[132:135], v231 offset:13312
    ds_read_b128 v[136:139], v231 offset:14336
    ds_read_b64_tr_b16 v[140:141], v235 offset:0
    ds_read_b64_tr_b16 v[142:143], v235 offset:512
    ds_read_b64_tr_b16 v[144:145], v235 offset:4096
    ds_read_b64_tr_b16 v[146:147], v235 offset:4608
    ds_read_b64_tr_b16 v[148:149], v236 offset:8192
    ds_read_b32 v238, v238
    s_waitcnt lgkmcnt(0)
    v_pk_add_f32 v[80:81], v[80:81], v[100:101]
    v_pk_add_f32 v[0:1], v[0:1], v[120:121]
    v_pk_add_f32 v[82:83], v[82:83], v[102:103]
    v_pk_add_f32 v[2:3], v[2:3], v[122:123]
    v_pk_add_f32 v[84:85], v[84:85], v[104:105]
    v_pk_add_f32 v[16:17], v[16:17], v[124:125]
    v_pk_add_f32 v[86:87], v[86:87], v[106:107]
    v_pk_add_f32 v[18:19], v[18:19], v[126:127]
    v_pk_add_f32 v[88:89], v[88:89], v[108:109]
    v_pk_add_f32 v[32:33], v[32:33], v[128:129]
    v_pk_add_f32 v[90:91], v[90:91], v[110:111]
    v_pk_add_f32 v[34:35], v[34:35], v[130:131]
    v_pk_add_f32 v[92:93], v[92:93], v[112:113]
    v_pk_add_f32 v[48:49], v[48:49], v[132:133]
    v_pk_add_f32 v[94:95], v[94:95], v[114:115]
    v_pk_add_f32 v[50:51], v[50:51], v[134:135]
    v_pk_add_f32 v[96:97], v[96:97], v[116:117]
    v_pk_add_f32 v[64:65], v[64:65], v[136:137]
    v_pk_add_f32 v[98:99], v[98:99], v[118:119]
    v_pk_add_f32 v[66:67], v[66:67], v[138:139]
    v_pk_add_f32 v[0:1], v[0:1], v[80:81]
    v_pk_add_f32 v[2:3], v[2:3], v[82:83]
    v_pk_add_f32 v[16:17], v[16:17], v[84:85]
    v_pk_add_f32 v[18:19], v[18:19], v[86:87]
    v_pk_add_f32 v[32:33], v[32:33], v[88:89]
    v_pk_add_f32 v[34:35], v[34:35], v[90:91]
    v_pk_add_f32 v[48:49], v[48:49], v[92:93]
    v_pk_add_f32 v[50:51], v[50:51], v[94:95]
    v_pk_add_f32 v[64:65], v[64:65], v[96:97]
    v_pk_add_f32 v[66:67], v[66:67], v[98:99]
    v_lshlrev_b32 v150, 16, v140
    v_and_b32 v151, 0xffff0000, v140
    v_lshlrev_b32 v152, 16, v141
    v_and_b32 v153, 0xffff0000, v141
    v_lshlrev_b32 v154, 16, v142
    v_and_b32 v155, 0xffff0000, v142
    v_lshlrev_b32 v156, 16, v143
    v_and_b32 v157, 0xffff0000, v143
    v_lshlrev_b32 v158, 16, v144
    v_and_b32 v159, 0xffff0000, v144
    v_lshlrev_b32 v160, 16, v145
    v_and_b32 v161, 0xffff0000, v145
    v_lshlrev_b32 v162, 16, v146
    v_and_b32 v163, 0xffff0000, v146
    v_lshlrev_b32 v164, 16, v147
    v_and_b32 v165, 0xffff0000, v147
    v_lshlrev_b32 v166, 16, v148
    v_and_b32 v167, 0xffff0000, v148
    v_lshlrev_b32 v168, 16, v149
    v_and_b32 v169, 0xffff0000, v149
    v_mov_b32 v242, v238
    v_mov_b32 v243, v238
    v_pk_add_f32 v[150:151], v[150:151], v[0:1] neg_lo:[0,1] neg_hi:[0,1]
    v_pk_add_f32 v[152:153], v[152:153], v[2:3] neg_lo:[0,1] neg_hi:[0,1]
    v_pk_add_f32 v[154:155], v[154:155], v[16:17] neg_lo:[0,1] neg_hi:[0,1]
    v_pk_add_f32 v[156:157], v[156:157], v[18:19] neg_lo:[0,1] neg_hi:[0,1]
    v_pk_add_f32 v[158:159], v[158:159], v[32:33] neg_lo:[0,1] neg_hi:[0,1]
    v_pk_add_f32 v[160:161], v[160:161], v[34:35] neg_lo:[0,1] neg_hi:[0,1]
    v_pk_add_f32 v[162:163], v[162:163], v[48:49] neg_lo:[0,1] neg_hi:[0,1]
    v_pk_add_f32 v[164:165], v[164:165], v[50:51] neg_lo:[0,1] neg_hi:[0,1]
    v_pk_add_f32 v[166:167], v[166:167], v[64:65] neg_lo:[0,1] neg_hi:[0,1]
    v_pk_add_f32 v[168:169], v[168:169], v[66:67] neg_lo:[0,1] neg_hi:[0,1]
    v_pk_fma_f32 v[0:1], v[150:151], v[242:243], v[0:1]
    v_pk_fma_f32 v[2:3], v[152:153], v[242:243], v[2:3]
    v_pk_fma_f32 v[16:17], v[154:155], v[242:243], v[16:17]
    v_pk_fma_f32 v[18:19], v[156:157], v[242:243], v[18:19]
    v_pk_fma_f32 v[32:33], v[158:159], v[242:243], v[32:33]
    v_pk_fma_f32 v[34:35], v[160:161], v[242:243], v[34:35]
    v_pk_fma_f32 v[48:49], v[162:163], v[242:243], v[48:49]
    v_pk_fma_f32 v[50:51], v[164:165], v[242:243], v[50:51]
    v_pk_fma_f32 v[64:65], v[166:167], v[242:243], v[64:65]
    v_pk_fma_f32 v[66:67], v[168:169], v[242:243], v[66:67]
    v_cvt_pk_bf16_f32 v176, v0, v1
    v_cvt_pk_bf16_f32 v177, v2, v3
    v_cvt_pk_bf16_f32 v178, v16, v17
    v_cvt_pk_bf16_f32 v179, v18, v19
    v_cvt_pk_bf16_f32 v180, v32, v33
    v_cvt_pk_bf16_f32 v181, v34, v35
    v_cvt_pk_bf16_f32 v182, v48, v49
    v_cvt_pk_bf16_f32 v183, v50, v51
    v_cvt_pk_bf16_f32 v184, v64, v65
    v_cvt_pk_bf16_f32 v185, v66, v67
    buffer_store_dwordx4 v[176:179], v239, s[24:27], 0 offen
    buffer_store_dwordx4 v[180:183], v239, s[24:27], 0 offen offset:64
    buffer_store_dwordx2 v[184:185], v240, s[24:27], 0 offen offset:128
    s_endpgm
gated_mix__ssm_conv_s4__swiglu_ffn__prompt_kernel_S:
    s_waitcnt lgkmcnt(0)
    s_mov_b32 s8, s32
    s_and_b32 s9, s33, 0xffff
    s_mov_b32 s10, 0x280000
    s_mov_b32 s11, 0x20000
    s_mov_b32 s12, s52
    s_and_b32 s13, s53, 0xffff
    s_mov_b32 s14, 0x1e0000
    s_mov_b32 s15, 0x20000
    s_mov_b32 s16, s54
    s_and_b32 s17, s55, 0xffff
    s_mov_b32 s18, 0x1e0000
    s_mov_b32 s19, 0x20000
    s_mov_b32 s20, s64
    s_and_b32 s21, s65, 0xffff
    s_mov_b32 s22, 0x10000000
    s_mov_b32 s23, 0x20000
    s_mov_b32 s24, s60
    s_and_b32 s25, s61, 0xffff
    s_mov_b32 s26, 0x280000
    s_mov_b32 s27, 0x20000
    s_mov_b32 s28, s56
    s_and_b32 s29, s57, 0xffff
    s_mov_b32 s30, 0x1e0000
    s_mov_b32 s31, 0x20000
    s_sub_u32 s66, s3, 4
    s_cmp_eq_u32 s66, 3
    s_cbranch_scc1 gated_mix__ssm_conv_s4__swiglu_ffn__prompt_kernel_sj
    s_lshl_b32 s50, s66, 8
    s_add_u32 s50, s50, s2
    s_min_u32 s50, s50, 639
    s_mul_i32 s51, s66, 8704
    s_add_u32 s51, s51, 122880
    s_mul_i32 s52, s66, 4224
    s_add_u32 s52, s52, 148992
    s_mul_i32 s67, s50, 384
    v_lshl_add_u32 v1, v0, 1, s67
    global_load_ushort v200, v1, s[34:35] offset:0
    global_load_ushort v201, v1, s[36:37] offset:0
    global_load_ushort v202, v1, s[38:39] offset:0
    global_load_ushort v203, v1, s[40:41] offset:0
    global_load_ushort v204, v1, s[42:43] offset:0
    global_load_ushort v205, v1, s[44:45] offset:0
    s_lshl_b32 s67, s50, 1
    v_mov_b32 v223, s67
    global_load_ushort v218, v223, s[46:47]
    global_load_ushort v219, v223, s[48:49]
    s_barrier
    s_waitcnt vmcnt(0)
    v_and_b32 v4, 15, v0
    v_lshrrev_b32 v5, 4, v0
    v_mul_u32_u24 v2, 272, v4
    v_lshl_add_u32 v2, v5, 6, v2
    v_add_u32 v2, s51, v2
    v_and_b32 v6, 1, v5
    v_lshl_add_u32 v3, v6, 3, v2
    v_xor_b32 v6, 1, v6
    v_lshl_add_u32 v2, v6, 3, v2
    s_mov_b32 m0, s51
    s_nop 0
    v_lshlrev_b32 v218, 16, v218
    v_lshlrev_b32 v219, 16, v219
    v_mul_f32 v6, 0x3fb8aa3b, v218
    s_mov_b32 s67, 0x3fb8aa3b
    v_fma_f32 v7, v218, s67, -v6
    v_fmac_f32 v7, 0x32a57060, v218
    v_exp_f32 v6, v6
    v_mul_f32 v7, 0x3f317218, v7
    v_fma_f32 v6, v6, v7, v6
    v_cvt_pk_bf16_f32 v6, v6, v6
    v_lshlrev_b32 v218, 16, v6
    v_lshlrev_b32 v200, 16, v200
    v_lshlrev_b32 v201, 16, v201
    v_lshlrev_b32 v202, 16, v202
    v_lshlrev_b32 v203, 16, v203
    v_lshlrev_b32 v204, 16, v204
    v_lshlrev_b32 v205, 16, v205
    v_mul_f32 v6, v218, v200
    v_mul_f32 v7, v218, v201
    v_mul_f32 v6, 0x3fb8aa3b, v6
    v_mul_f32 v7, 0.15915494, v7
    v_mul_f32 v8, v218, v202
    v_mul_f32 v9, v218, v203
    v_mul_f32 v30, v205, v9
    v_mul_f32 v31, v204, v9
    v_fma_f32 v24, v204, v8, -v30
    v_fma_f32 v25, v205, v8, v31
    v_exp_f32 v32, v6
    v_fract_f32 v34, v7
    v_cos_f32 v10, v34
    v_sin_f32 v11, v34
    s_nop 0
    v_mul_f32 v10, v10, v32
    v_mul_f32 v11, v11, v32
    v_mul_f32 v32, 0x41800000, v6
    v_mul_f32 v34, 0x41800000, v7
    v_exp_f32 v32, v32
    v_fract_f32 v34, v34
    v_cos_f32 v12, v34
    v_sin_f32 v13, v34
    s_nop 0
    v_mul_f32 v12, v12, v32
    v_mul_f32 v13, v13, v32
    v_mul_f32 v32, 0x43800000, v6
    v_mul_f32 v34, 0x43800000, v7
    v_exp_f32 v32, v32
    v_fract_f32 v34, v34
    v_cos_f32 v14, v34
    v_sin_f32 v15, v34
    s_nop 0
    v_mul_f32 v14, v14, v32
    v_mul_f32 v15, v15, v32
    v_mov_b32 v26, v24
    v_mov_b32 v28, 1.0
    v_mov_b32 v27, v25
    v_mov_b32 v29, 0
    v_cvt_pk_bf16_f32 v66, v26, v27
    v_cvt_pk_bf16_f32 v70, v28, -v29
    ds_write_addtid_b32 v66 offset:0
    ds_write_addtid_b32 v70 offset:4352
    v_mul_f32 v30, v27, v13
    v_mov_b32 v28, v10
    v_mul_f32 v31, v26, v13
    v_mov_b32 v29, v11
    v_fma_f32 v26, v26, v12, -v30
    v_cvt_pk_bf16_f32 v71, v28, -v29
    v_fma_f32 v27, v27, v12, v31
    ds_write_addtid_b32 v71 offset:4624
    v_cvt_pk_bf16_f32 v67, v26, v27
    v_mul_f32 v32, v29, v11
    ds_write_addtid_b32 v67 offset:272
    v_mul_f32 v33, v28, v11
    v_mul_f32 v30, v27, v13
    v_fma_f32 v36, v28, v10, -v32
    v_mul_f32 v31, v26, v13
    v_fma_f32 v37, v29, v10, v33
    v_fma_f32 v26, v26, v12, -v30
    v_cvt_pk_bf16_f32 v72, v36, -v37
    v_fma_f32 v27, v27, v12, v31
    ds_write_addtid_b32 v72 offset:4896
    v_cvt_pk_bf16_f32 v68, v26, v27
    v_mul_f32 v32, v37, v11
    ds_write_addtid_b32 v68 offset:544
    v_mul_f32 v33, v36, v11
    v_mul_f32 v30, v27, v13
    v_fma_f32 v28, v36, v10, -v32
    v_mul_f32 v31, v26, v13
    v_fma_f32 v29, v37, v10, v33
    v_fma_f32 v26, v26, v12, -v30
    v_cvt_pk_bf16_f32 v73, v28, -v29
    v_fma_f32 v27, v27, v12, v31
    ds_write_addtid_b32 v73 offset:5168
    v_cvt_pk_bf16_f32 v69, v26, v27
    v_mul_f32 v32, v29, v11
    ds_write_addtid_b32 v69 offset:816
    v_mul_f32 v33, v28, v11
    v_mul_f32 v30, v27, v13
    v_fma_f32 v38, v28, v10, -v32
    v_mul_f32 v31, v26, v13
    v_fma_f32 v39, v29, v10, v33
    v_fma_f32 v26, v26, v12, -v30
    v_cvt_pk_bf16_f32 v70, v38, -v39
    v_fma_f32 v27, v27, v12, v31
    ds_write_addtid_b32 v70 offset:5440
    v_cvt_pk_bf16_f32 v66, v26, v27
    v_mul_f32 v32, v39, v11
    ds_write_addtid_b32 v66 offset:1088
    v_mul_f32 v33, v38, v11
    v_mul_f32 v30, v27, v13
    v_fma_f32 v28, v38, v10, -v32
    v_mul_f32 v31, v26, v13
    v_fma_f32 v29, v39, v10, v33
    v_fma_f32 v26, v26, v12, -v30
    v_cvt_pk_bf16_f32 v71, v28, -v29
    v_fma_f32 v27, v27, v12, v31
    ds_write_addtid_b32 v71 offset:5712
    v_cvt_pk_bf16_f32 v67, v26, v27
    v_mul_f32 v32, v29, v11
    ds_write_addtid_b32 v67 offset:1360
    v_mul_f32 v33, v28, v11
    v_mul_f32 v30, v27, v13
    v_fma_f32 v40, v28, v10, -v32
    v_mul_f32 v31, v26, v13
    v_fma_f32 v41, v29, v10, v33
    v_fma_f32 v26, v26, v12, -v30
    v_cvt_pk_bf16_f32 v72, v40, -v41
    v_fma_f32 v27, v27, v12, v31
    ds_write_addtid_b32 v72 offset:5984
    v_cvt_pk_bf16_f32 v68, v26, v27
    s_barrier
    v_mul_f32 v32, v41, v11
    ds_write_addtid_b32 v68 offset:1632
    v_mul_f32 v33, v40, v11
    v_mul_f32 v30, v27, v13
    v_fma_f32 v28, v40, v10, -v32
    v_mul_f32 v31, v26, v13
    v_fma_f32 v29, v41, v10, v33
    v_fma_f32 v26, v26, v12, -v30
    v_cvt_pk_bf16_f32 v73, v28, -v29
    v_fma_f32 v27, v27, v12, v31
    ds_write_addtid_b32 v73 offset:6256
    v_cvt_pk_bf16_f32 v69, v26, v27
    v_mul_f32 v32, v29, v11
    ds_write_addtid_b32 v69 offset:1904
    v_mul_f32 v33, v28, v11
    v_mul_f32 v30, v27, v13
    v_fma_f32 v42, v28, v10, -v32
    v_mul_f32 v31, v26, v13
    v_fma_f32 v43, v29, v10, v33
    v_fma_f32 v26, v26, v12, -v30
    v_cvt_pk_bf16_f32 v70, v42, -v43
    v_fma_f32 v27, v27, v12, v31
    ds_write_addtid_b32 v70 offset:6528
    v_cvt_pk_bf16_f32 v66, v26, v27
    v_mul_f32 v32, v43, v11
    ds_write_addtid_b32 v66 offset:2176
    v_mul_f32 v33, v42, v11
    v_mul_f32 v30, v27, v13
    v_fma_f32 v28, v42, v10, -v32
    v_mul_f32 v31, v26, v13
    v_fma_f32 v29, v43, v10, v33
    v_fma_f32 v26, v26, v12, -v30
    v_cvt_pk_bf16_f32 v71, v28, -v29
    v_fma_f32 v27, v27, v12, v31
    ds_write_addtid_b32 v71 offset:6800
    v_cvt_pk_bf16_f32 v67, v26, v27
    v_mul_f32 v32, v29, v11
    ds_write_addtid_b32 v67 offset:2448
    s_barrier
    v_mul_f32 v33, v28, v11
    v_mul_f32 v30, v27, v13
    v_fma_f32 v44, v28, v10, -v32
    v_mul_f32 v31, v26, v13
    v_fma_f32 v45, v29, v10, v33
    v_fma_f32 v26, v26, v12, -v30
    v_cvt_pk_bf16_f32 v72, v44, -v45
    v_fma_f32 v27, v27, v12, v31
    ds_write_addtid_b32 v72 offset:7072
    v_cvt_pk_bf16_f32 v68, v26, v27
    v_mul_f32 v32, v45, v11
    ds_write_addtid_b32 v68 offset:2720
    v_mul_f32 v33, v44, v11
    v_mul_f32 v30, v27, v13
    v_fma_f32 v28, v44, v10, -v32
    v_mul_f32 v31, v26, v13
    v_fma_f32 v29, v45, v10, v33
    v_fma_f32 v26, v26, v12, -v30
    v_cvt_pk_bf16_f32 v73, v28, -v29
    v_fma_f32 v27, v27, v12, v31
    ds_write_addtid_b32 v73 offset:7344
    v_cvt_pk_bf16_f32 v69, v26, v27
    v_mul_f32 v32, v29, v11
    ds_write_addtid_b32 v69 offset:2992
    v_mul_f32 v33, v28, v11
    v_mul_f32 v30, v27, v13
    v_fma_f32 v46, v28, v10, -v32
    v_mul_f32 v31, v26, v13
    v_fma_f32 v47, v29, v10, v33
    v_fma_f32 v26, v26, v12, -v30
    v_cvt_pk_bf16_f32 v70, v46, -v47
    v_fma_f32 v27, v27, v12, v31
    ds_write_addtid_b32 v70 offset:7616
    v_cvt_pk_bf16_f32 v66, v26, v27
    v_mul_f32 v32, v47, v11
    ds_write_addtid_b32 v66 offset:3264
    v_mul_f32 v33, v46, v11
    v_mul_f32 v30, v27, v13
    s_barrier
    v_fma_f32 v28, v46, v10, -v32
    v_mul_f32 v31, v26, v13
    v_fma_f32 v29, v47, v10, v33
    v_fma_f32 v26, v26, v12, -v30
    v_cvt_pk_bf16_f32 v71, v28, -v29
    v_fma_f32 v27, v27, v12, v31
    ds_write_addtid_b32 v71 offset:7888
    v_cvt_pk_bf16_f32 v67, v26, v27
    v_mul_f32 v32, v29, v11
    ds_write_addtid_b32 v67 offset:3536
    v_mul_f32 v33, v28, v11
    v_mul_f32 v30, v27, v13
    v_fma_f32 v48, v28, v10, -v32
    v_mul_f32 v31, v26, v13
    v_fma_f32 v49, v29, v10, v33
    v_fma_f32 v26, v26, v12, -v30
    v_cvt_pk_bf16_f32 v72, v48, -v49
    v_fma_f32 v27, v27, v12, v31
    ds_write_addtid_b32 v72 offset:8160
    v_cvt_pk_bf16_f32 v68, v26, v27
    v_mul_f32 v32, v49, v11
    ds_write_addtid_b32 v68 offset:3808
    v_mul_f32 v33, v48, v11
    v_mul_f32 v30, v27, v13
    v_fma_f32 v28, v48, v10, -v32
    v_mul_f32 v31, v26, v13
    v_fma_f32 v29, v49, v10, v33
    v_fma_f32 v26, v26, v12, -v30
    v_cvt_pk_bf16_f32 v73, v28, -v29
    v_fma_f32 v27, v27, v12, v31
    ds_write_addtid_b32 v73 offset:8432
    v_cvt_pk_bf16_f32 v69, v26, v27
    ds_write_addtid_b32 v69 offset:4080
    v_mul_f32 v30, v15, v15
    v_mul_f32 v31, v14, v15
    v_fma_f32 v16, v14, v14, -v30
    v_fma_f32 v17, v15, v14, v31
    ds_read_b64 v[76:77], v3 offset:0
    s_barrier
    ds_read_b64 v[78:79], v2 offset:0
    ds_read_b64 v[80:81], v3 offset:16
    ds_read_b64 v[82:83], v2 offset:16
    ds_read_b64 v[84:85], v3 offset:32
    ds_read_b64 v[86:87], v2 offset:32
    ds_read_b64 v[88:89], v3 offset:48
    ds_read_b64 v[90:91], v2 offset:48
    ds_read_b64 v[92:93], v3 offset:4352
    ds_read_b64 v[94:95], v2 offset:4352
    ds_read_b64 v[96:97], v3 offset:4368
    ds_read_b64 v[98:99], v2 offset:4368
    ds_read_b64 v[100:101], v3 offset:4384
    ds_read_b64 v[102:103], v2 offset:4384
    ds_read_b64 v[104:105], v3 offset:4400
    ds_read_b64 v[106:107], v2 offset:4400
    v_mul_f32 v30, v17, v15
    v_mul_f32 v32, v17, v17
    v_mul_f32 v31, v16, v15
    v_mul_f32 v33, v16, v17
    v_fma_f32 v18, v16, v14, -v30
    v_fma_f32 v20, v16, v16, -v32
    v_fma_f32 v19, v17, v14, v31
    v_fma_f32 v21, v17, v16, v33
    v_mul_f32 v30, v37, v15
    v_mul_f32 v32, v39, v15
    v_mul_f32 v31, v36, v15
    v_mul_f32 v33, v38, v15
    v_fma_f32 v50, v36, v14, -v30
    v_fma_f32 v52, v38, v14, -v32
    v_fma_f32 v51, v37, v14, v31
    v_fma_f32 v53, v39, v14, v33
    v_mul_f32 v30, v41, v15
    v_mul_f32 v32, v43, v15
    v_mul_f32 v31, v40, v15
    v_mul_f32 v33, v42, v15
    v_fma_f32 v54, v40, v14, -v30
    v_fma_f32 v56, v42, v14, -v32
    v_fma_f32 v55, v41, v14, v31
    s_barrier
    v_fma_f32 v57, v43, v14, v33
    v_mul_f32 v30, v45, v15
    v_mul_f32 v32, v47, v15
    v_mul_f32 v31, v44, v15
    v_mul_f32 v33, v46, v15
    v_fma_f32 v58, v44, v14, -v30
    v_fma_f32 v60, v46, v14, -v32
    v_fma_f32 v59, v45, v14, v31
    v_fma_f32 v61, v47, v14, v33
    v_mul_f32 v30, v49, v15
    v_mul_f32 v31, v48, v15
    v_fma_f32 v62, v48, v14, -v30
    v_fma_f32 v63, v49, v14, v31
    s_waitcnt lgkmcnt(0)
    v_mfma_f32_16x16x32_bf16 v[108:111], v[92:95], v[76:79], 0
    v_cvt_pk_bf16_f32 v66, v14, -v15
    ds_write_addtid_b32 v66 offset:4352
    v_cvt_pk_bf16_f32 v67, v50, -v51
    ds_write_addtid_b32 v67 offset:4624
    v_mfma_f32_16x16x32_bf16 v[108:111], v[96:99], v[80:83], v[108:111]
    v_cvt_pk_bf16_f32 v68, v52, -v53
    ds_write_addtid_b32 v68 offset:4896
    v_cvt_pk_bf16_f32 v69, v54, -v55
    ds_write_addtid_b32 v69 offset:5168
    v_mfma_f32_16x16x32_bf16 v[108:111], v[100:103], v[84:87], v[108:111]
    v_cvt_pk_bf16_f32 v66, v56, -v57
    ds_write_addtid_b32 v66 offset:5440
    v_cvt_pk_bf16_f32 v67, v58, -v59
    ds_write_addtid_b32 v67 offset:5712
    v_mfma_f32_16x16x32_bf16 v[108:111], v[104:107], v[88:91], v[108:111]
    v_cvt_pk_bf16_f32 v68, v60, -v61
    ds_write_addtid_b32 v68 offset:5984
    v_cvt_pk_bf16_f32 v69, v62, -v63
    ds_write_addtid_b32 v69 offset:6256
    v_cvt_pk_bf16_f32 v66, v16, -v17
    v_cvt_pk_bf16_f32 v70, v18, -v19
    ds_write_addtid_b32 v66 offset:6528
    ds_write_addtid_b32 v70 offset:7616
    s_barrier
    v_mul_f32 v30, v39, v17
    v_mul_f32 v32, v39, v19
    v_mul_f32 v31, v38, v17
    v_mul_f32 v33, v38, v19
    v_fma_f32 v50, v38, v16, -v30
    v_fma_f32 v52, v38, v18, -v32
    v_fma_f32 v51, v39, v16, v31
    v_fma_f32 v53, v39, v18, v33
    v_cvt_pk_bf16_f32 v67, v50, -v51
    v_cvt_pk_bf16_f32 v71, v52, -v53
    ds_write_addtid_b32 v67 offset:6800
    ds_write_addtid_b32 v71 offset:7888
    v_mul_f32 v30, v43, v17
    v_mul_f32 v32, v43, v19
    v_mul_f32 v31, v42, v17
    v_mul_f32 v33, v42, v19
    v_fma_f32 v50, v42, v16, -v30
    v_fma_f32 v52, v42, v18, -v32
    v_fma_f32 v51, v43, v16, v31
    v_fma_f32 v53, v43, v18, v33
    v_cvt_pk_bf16_f32 v68, v50, -v51
    v_cvt_pk_bf16_f32 v72, v52, -v53
    ds_write_addtid_b32 v68 offset:7072
    ds_write_addtid_b32 v72 offset:8160
    v_mul_f32 v30, v47, v17
    v_mul_f32 v32, v47, v19
    v_mul_f32 v31, v46, v17
    v_mul_f32 v33, v46, v19
    v_fma_f32 v50, v46, v16, -v30
    v_fma_f32 v52, v46, v18, -v32
    v_fma_f32 v51, v47, v16, v31
    v_fma_f32 v53, v47, v18, v33
    v_cvt_pk_bf16_f32 v69, v50, -v51
    v_cvt_pk_bf16_f32 v73, v52, -v53
    ds_write_addtid_b32 v69 offset:7344
    ds_write_addtid_b32 v73 offset:8432
    ds_read_b64 v[92:93], v3 offset:4352
    ds_read_b64 v[94:95], v2 offset:4352
    s_barrier
    ds_read_b64 v[96:97], v3 offset:4368
    ds_read_b64 v[98:99], v2 offset:4368
    ds_read_b64 v[100:101], v3 offset:4384
    ds_read_b64 v[102:103], v2 offset:4384
    ds_read_b64 v[104:105], v3 offset:4400
    ds_read_b64 v[106:107], v2 offset:4400
    v_mul_f32 v30, v21, v15
    v_mul_f32 v32, v21, v17
    v_mul_f32 v31, v20, v15
    v_mul_f32 v33, v20, v17
    v_fma_f32 v50, v20, v14, -v30
    v_fma_f32 v52, v20, v16, -v32
    v_fma_f32 v51, v21, v14, v31
    v_fma_f32 v53, v21, v16, v33
    v_mul_f32 v30, v21, v19
    v_mul_f32 v32, v21, v21
    v_mul_f32 v31, v20, v19
    v_mul_f32 v33, v20, v21
    v_fma_f32 v54, v20, v18, -v30
    v_fma_f32 v56, v20, v20, -v32
    v_fma_f32 v55, v21, v18, v31
    v_fma_f32 v57, v21, v20, v33
    v_mul_f32 v30, v21, v43
    v_mul_f32 v32, v51, v43
    v_mul_f32 v31, v20, v43
    v_mul_f32 v33, v50, v43
    v_fma_f32 v58, v20, v42, -v30
    v_fma_f32 v60, v50, v42, -v32
    v_fma_f32 v59, v21, v42, v31
    v_fma_f32 v61, v51, v42, v33
    v_mul_f32 v30, v53, v43
    v_mul_f32 v32, v55, v43
    v_mul_f32 v31, v52, v43
    v_mul_f32 v33, v54, v43
    v_fma_f32 v62, v52, v42, -v30
    v_fma_f32 v64, v54, v42, -v32
    v_fma_f32 v63, v53, v42, v31
    v_fma_f32 v65, v55, v42, v33
    s_barrier
    s_mul_i32 s67, s50, 384
    v_lshl_add_u32 v1, v0, 1, s67
    global_load_ushort v206, v1, s[34:35] offset:128
    global_load_ushort v207, v1, s[36:37] offset:128
    global_load_ushort v208, v1, s[38:39] offset:128
    global_load_ushort v209, v1, s[40:41] offset:128
    global_load_ushort v210, v1, s[42:43] offset:128
    global_load_ushort v211, v1, s[44:45] offset:128
    global_load_ushort v212, v1, s[34:35] offset:256
    global_load_ushort v213, v1, s[36:37] offset:256
    global_load_ushort v214, v1, s[38:39] offset:256
    global_load_ushort v215, v1, s[40:41] offset:256
    global_load_ushort v216, v1, s[42:43] offset:256
    global_load_ushort v217, v1, s[44:45] offset:256
    s_waitcnt lgkmcnt(0)
    v_mfma_f32_16x16x32_bf16 v[112:115], v[92:95], v[76:79], 0
    v_cvt_pk_bf16_f32 v66, v20, -v21
    ds_write_addtid_b32 v66 offset:4352
    v_cvt_pk_bf16_f32 v67, v58, -v59
    ds_write_addtid_b32 v67 offset:4624
    v_cvt_pk_bf16_f32 v68, v50, -v51
    v_mfma_f32_16x16x32_bf16 v[112:115], v[96:99], v[80:83], v[112:115]
    ds_write_addtid_b32 v68 offset:4896
    v_cvt_pk_bf16_f32 v69, v60, -v61
    ds_write_addtid_b32 v69 offset:5168
    v_cvt_pk_bf16_f32 v66, v52, -v53
    v_mfma_f32_16x16x32_bf16 v[112:115], v[100:103], v[84:87], v[112:115]
    ds_write_addtid_b32 v66 offset:5440
    v_cvt_pk_bf16_f32 v67, v62, -v63
    ds_write_addtid_b32 v67 offset:5712
    v_cvt_pk_bf16_f32 v68, v54, -v55
    ds_write_addtid_b32 v68 offset:5984
    v_mfma_f32_16x16x32_bf16 v[112:115], v[104:107], v[88:91], v[112:115]
    v_cvt_pk_bf16_f32 v69, v64, -v65
    ds_write_addtid_b32 v69 offset:6256
    v_cvt_pk_bf16_f32 v66, v56, -v57
    ds_write_addtid_b32 v66 offset:6528
    ds_read_b64 v[92:93], v3 offset:4352
    ds_read_b64 v[94:95], v2 offset:4352
    ds_read_b64 v[96:97], v3 offset:4368
    ds_read_b64 v[98:99], v2 offset:4368
    ds_read_b64 v[100:101], v3 offset:4384
    ds_read_b64 v[102:103], v2 offset:4384
    ds_read_b64 v[104:105], v3 offset:4400
    ds_read_b64 v[106:107], v2 offset:4400
    s_waitcnt lgkmcnt(0)
    v_mfma_f32_16x16x32_bf16 v[116:119], v[92:95], v[76:79], 0
    v_mfma_f32_16x16x32_bf16 v[116:119], v[96:99], v[80:83], v[116:119]
    v_mfma_f32_16x16x32_bf16 v[116:119], v[100:103], v[84:87], v[116:119]
    v_mfma_f32_16x16x32_bf16 v[116:119], v[104:107], v[88:91], v[116:119]
    s_barrier
    s_branch gated_mix__ssm_conv_s4__swiglu_ffn__prompt_kernel_p1done
gated_mix__ssm_conv_s4__swiglu_ffn__prompt_kernel_sj:
    s_mov_b32 s67, 52429
    s_movk_i32 s68, 1280
    v_add_u32 v1, 0, v0
    v_mul_lo_u32 v2, v1, s67
    v_lshrrev_b32 v2, 19, v2
    v_mul_u32_u24 v3, 10, v2
    v_sub_u32 v3, v1, v3
    v_mul_lo_u32 v2, v2, s68
    v_lshl_add_u32 v230, v3, 4, v2
    v_add_u32 v1, 64, v0
    v_mul_lo_u32 v2, v1, s67
    v_lshrrev_b32 v2, 19, v2
    v_mul_u32_u24 v3, 10, v2
    v_sub_u32 v3, v1, v3
    v_mul_lo_u32 v2, v2, s68
    v_lshl_add_u32 v231, v3, 4, v2
    v_add_u32 v1, 128, v0
    v_mul_lo_u32 v2, v1, s67
    v_lshrrev_b32 v2, 19, v2
    v_mul_u32_u24 v3, 10, v2
    v_sub_u32 v3, v1, v3
    v_mul_lo_u32 v2, v2, s68
    v_lshl_add_u32 v232, v3, 4, v2
    v_add_u32 v1, 192, v0
    v_mul_lo_u32 v2, v1, s67
    v_lshrrev_b32 v2, 19, v2
    v_mul_u32_u24 v3, 10, v2
    v_sub_u32 v3, v1, v3
    v_mul_lo_u32 v2, v2, s68
    v_lshl_add_u32 v233, v3, 4, v2
    v_add_u32 v1, 256, v0
    v_mul_lo_u32 v2, v1, s67
    v_lshrrev_b32 v2, 19, v2
    v_mul_u32_u24 v3, 10, v2
    v_sub_u32 v3, v1, v3
    v_mul_lo_u32 v2, v2, s68
    v_lshl_add_u32 v234, v3, 4, v2
    v_lshrrev_b32 v1, 4, v0
    v_and_b32 v2, 15, v0
    v_lshrrev_b32 v3, 2, v2
    v_lshl_add_u32 v4, v1, 2, v3
    v_mul_u32_u24 v4, 160, v4
    v_add_u32 v4, 40960, v4
    v_and_b32 v5, 3, v0
    v_lshl_add_u32 v235, v5, 4, v4
    v_lshl_add_u32 v236, v5, 3, v4
    v_lshlrev_b32 v237, 4, v0
    v_lshlrev_b32 v241, 2, v0
    v_lshl_add_u32 v4, v1, 3, v3
    v_lshlrev_b32 v4, 7, v4
    v_bfe_u32 v5, v0, 1, 1
    v_lshrrev_b32 v6, 1, v3
    v_xor_b32 v5, v5, v6
    v_lshl_add_u32 v4, v5, 4, v4
    v_and_b32 v5, 1, v0
    v_lshl_add_u32 v4, v5, 3, v4
    v_and_b32 v5, 1, v1
    v_lshl_add_u32 v238, v5, 6, v4
    v_xor_b32 v5, 1, v5
    v_lshl_add_u32 v239, v5, 6, v4
    v_mul_u32_u24 v240, 4224, v2
    v_lshl_add_u32 v240, v1, 4, v240
    s_add_u32 s51, s2, 128
    s_cmp_ge_u32 s2, 128
    s_cselect_b32 s51, s51, 999
    s_lshr_b32 s52, s5, 1
    s_add_u32 s53, s52, 8
    s_cmp_lt_u32 s5, 4
    s_cselect_b32 s53, s53, 99
    s_lshr_b32 s50, s5, 1
    s_cmp_ge_u32 s50, 5
    s_cselect_b32 s67, 1, 0
    s_cmp_ge_u32 s50, 1
    s_addc_u32 s50, s50, s67
    s_and_b32 s68, s5, 1
    s_lshl_b32 s50, s50, 1
    s_add_u32 s50, s50, s68
    s_add_u32 s53, s50, 2
    s_lshr_b32 s67, s5, 1
    s_and_b32 s67, s67, 3
    s_cmp_eq_u32 s67, 0
    s_cselect_b32 s53, s53, 99
    v_mov_b32 v1, 161672
    v_mov_b32 v2, 0
    v_mov_b32 v3, 0
    ds_write_b64 v1, v[2:3]
    ds_write_b64 v1, v[2:3] offset:8
    ds_write_b64 v1, v[2:3] offset:16
    ds_write_b32 v1, v2 offset:24
    v_mov_b32 v1, 0
    s_mov_b32 s67, 14757888
    buffer_load_dword v242, v1, s[20:23], s67 offen sc1
    v_lshlrev_b32 v1, 7, v0
    s_mov_b32 exec_hi, 0x0fffffff
    s_mul_i32 s67, s2, 7680
    buffer_load_dword v244, v1, s[12:15], s67 offen
    buffer_load_dword v244, v1, s[16:19], s67 offen
    s_mov_b64 exec, -1
    s_barrier
    s_and_b32 s67, s50, 1
    s_cmp_eq_u32 s67, 0
    s_cselect_b64 vcc, -1, 0
    s_nop 0
    v_cndmask_b32 v4, v239, v238, vcc
    v_add_u32 v4, 0, v4
    ds_read_b64_tr_b16 v[100:101], v4 offset:0
    ds_read_b64_tr_b16 v[102:103], v4 offset:544
    ds_read_b64_tr_b16 v[104:105], v4 offset:4096
    ds_read_b64_tr_b16 v[106:107], v4 offset:4640
    ds_read_b64_tr_b16 v[108:109], v4 offset:8192
    ds_read_b64_tr_b16 v[110:111], v4 offset:8736
    ds_read_b64_tr_b16 v[112:113], v4 offset:12288
    ds_read_b64_tr_b16 v[114:115], v4 offset:12832
    ds_read_b64_tr_b16 v[116:117], v4 offset:32
    ds_read_b64_tr_b16 v[118:119], v4 offset:512
    ds_read_b64_tr_b16 v[120:121], v4 offset:4128
    ds_read_b64_tr_b16 v[122:123], v4 offset:4608
    ds_read_b64_tr_b16 v[124:125], v4 offset:8224
    ds_read_b64_tr_b16 v[126:127], v4 offset:8704
    ds_read_b64_tr_b16 v[128:129], v4 offset:12320
    ds_read_b64_tr_b16 v[130:131], v4 offset:12800
    s_waitcnt lgkmcnt(0)
    s_barrier
    s_cmp_ge_u32 s53, 20
    s_cbranch_scc1 L_gated__ut_26
    s_and_b32 s67, s53, 1
    s_cmp_eq_u32 s67, 0
    s_cselect_b64 vcc, -1, 0
    s_nop 0
    v_cndmask_b32 v4, v239, v238, vcc
    v_add_u32 v4, 40960, v4
    ds_read_b64_tr_b16 v[132:133], v4 offset:0
    ds_read_b64_tr_b16 v[134:135], v4 offset:544
    ds_read_b64_tr_b16 v[136:137], v4 offset:4096
    ds_read_b64_tr_b16 v[138:139], v4 offset:4640
    ds_read_b64_tr_b16 v[140:141], v4 offset:8192
    ds_read_b64_tr_b16 v[142:143], v4 offset:8736
    ds_read_b64_tr_b16 v[144:145], v4 offset:12288
    ds_read_b64_tr_b16 v[146:147], v4 offset:12832
    ds_read_b64_tr_b16 v[148:149], v4 offset:32
    ds_read_b64_tr_b16 v[150:151], v4 offset:512
    ds_read_b64_tr_b16 v[152:153], v4 offset:4128
    ds_read_b64_tr_b16 v[154:155], v4 offset:4608
    ds_read_b64_tr_b16 v[156:157], v4 offset:8224
    ds_read_b64_tr_b16 v[158:159], v4 offset:8704
    ds_read_b64_tr_b16 v[160:161], v4 offset:12320
    ds_read_b64_tr_b16 v[162:163], v4 offset:12800
    s_waitcnt lgkmcnt(0)
L_gated__ut_26:
    s_barrier
    s_mul_i32 s67, s50, 135168
    s_lshl_b32 s68, s4, 8
    s_add_u32 s67, s67, s68
    s_add_u32 s67, s67, 8388608
    s_add_u32 s68, s67, 67584
    buffer_store_dwordx4 v[100:103], v240, s[20:23], s67 offen offset:0 sc1
    buffer_store_dwordx4 v[104:107], v240, s[20:23], s67 offen offset:64 sc1
    buffer_store_dwordx4 v[108:111], v240, s[20:23], s67 offen offset:128 sc1
    buffer_store_dwordx4 v[112:115], v240, s[20:23], s67 offen offset:192 sc1
    buffer_store_dwordx4 v[116:119], v240, s[20:23], s68 offen offset:0 sc1
    buffer_store_dwordx4 v[120:123], v240, s[20:23], s68 offen offset:64 sc1
    buffer_store_dwordx4 v[124:127], v240, s[20:23], s68 offen offset:128 sc1
    buffer_store_dwordx4 v[128:131], v240, s[20:23], s68 offen offset:192 sc1
    s_cmp_ge_u32 s53, 20
    s_cbranch_scc1 L_gated__ut_27
    s_mul_i32 s67, s53, 135168
    s_lshl_b32 s68, s4, 8
    s_add_u32 s67, s67, s68
    s_add_u32 s67, s67, 8388608
    s_add_u32 s68, s67, 67584
    buffer_store_dwordx4 v[132:135], v240, s[20:23], s67 offen offset:0 sc1
    buffer_store_dwordx4 v[136:139], v240, s[20:23], s67 offen offset:64 sc1
    buffer_store_dwordx4 v[140:143], v240, s[20:23], s67 offen offset:128 sc1
    buffer_store_dwordx4 v[144:147], v240, s[20:23], s67 offen offset:192 sc1
    buffer_store_dwordx4 v[148:151], v240, s[20:23], s68 offen offset:0 sc1
    buffer_store_dwordx4 v[152:155], v240, s[20:23], s68 offen offset:64 sc1
    buffer_store_dwordx4 v[156:159], v240, s[20:23], s68 offen offset:128 sc1
    buffer_store_dwordx4 v[160:163], v240, s[20:23], s68 offen offset:192 sc1
L_gated__ut_27:
    s_barrier
    s_barrier
    s_waitcnt vmcnt(0)
    v_add_u32 v242, 1, v242
    v_mov_b32 v1, 161664
    ds_write_b32 v1, v242
    v_readfirstlane_b32 s64, v242
    s_lshl_b32 s69, s50, 5
    s_add_u32 s69, s69, s4
    s_lshl_b32 s69, s69, 2
    s_add_u32 s69, s69, 14745600
    v_mov_b32 v2, s64
    v_mov_b32 v3, 0
    s_mov_b64 exec, 1
    buffer_store_dword v2, v3, s[20:23], s69 offen sc1
    s_mov_b64 exec, -1
    s_cmp_ge_u32 s53, 20
    s_cbranch_scc1 L_gated__ut_28
    s_lshl_b32 s69, s53, 5
    s_add_u32 s69, s69, s4
    s_lshl_b32 s69, s69, 2
    s_add_u32 s69, s69, 14745600
    v_mov_b32 v2, s64
    v_mov_b32 v3, 0
    s_mov_b64 exec, 1
    buffer_store_dword v2, v3, s[20:23], s69 offen sc1
    s_mov_b64 exec, -1
L_gated__ut_28:
    s_barrier
    s_barrier
    s_barrier
    s_barrier
    v_lshrrev_b32 v1, 4, v0
    v_lshlrev_b32 v1, 8, v1
    v_add_u32 v1, s2, v1
    v_mov_b32 v2, s2
    v_cmp_gt_u32 vcc, 640, v1
    s_nop 1
    v_cndmask_b32 v1, v2, v1, vcc
    v_lshrrev_b32 v1, 5, v1
    v_lshlrev_b32 v1, 7, v1
    v_and_b32 v2, 15, v0
    v_lshl_add_u32 v1, v2, 2, v1
    v_add_u32 v90, 14745600, v1
    buffer_load_dword v92, v90, s[20:23], 0 offen sc1
    s_lshr_b32 s67, s2, 3
    s_and_b32 s68, s2, 7
    s_mul_i32 s69, s67, 40960
    s_mul_i32 s67, s68, 160
    s_add_u32 s69, s69, s67
    s_mov_b32 m0, 40960
    s_nop 0
    buffer_load_dwordx4 v230, s[28:31], s69 offen lds
    s_mov_b32 m0, 41984
    s_nop 0
    buffer_load_dwordx4 v231, s[28:31], s69 offen lds
    s_mov_b32 m0, 43008
    s_nop 0
    buffer_load_dwordx4 v232, s[28:31], s69 offen lds
    s_mov_b32 m0, 44032
    s_nop 0
    buffer_load_dwordx4 v233, s[28:31], s69 offen lds
    s_mov_b32 m0, 45056
    s_nop 0
    buffer_load_dwordx4 v234, s[28:31], s69 offen lds
    s_cmp_ge_u32 s51, 384
    s_cbranch_scc1 L_gated__wb_29
    s_lshr_b32 s67, s51, 3
    s_and_b32 s68, s51, 7
    s_mul_i32 s69, s67, 40960
    s_mul_i32 s67, s68, 160
    s_add_u32 s69, s69, s67
    s_mov_b32 m0, 46080
    s_nop 0
    buffer_load_dwordx4 v230, s[28:31], s69 offen lds
    s_mov_b32 m0, 47104
    s_nop 0
    buffer_load_dwordx4 v231, s[28:31], s69 offen lds
    s_mov_b32 m0, 48128
    s_nop 0
    buffer_load_dwordx4 v232, s[28:31], s69 offen lds
    s_mov_b32 m0, 49152
    s_nop 0
    buffer_load_dwordx4 v233, s[28:31], s69 offen lds
    s_mov_b32 m0, 50176
    s_nop 0
    buffer_load_dwordx4 v234, s[28:31], s69 offen lds
L_gated__wb_29:
    s_barrier
    s_waitcnt vmcnt(5)
    v_cmp_eq_u32 vcc, s64, v92
    s_nop 1
    s_cmp_eq_u64 vcc, -1
    s_cbranch_scc1 L_gated__uw_30
    s_mov_b32 s69, 0
L_gated__pl_31:
    buffer_load_dword v92, v90, s[20:23], 0 offen sc1
    s_waitcnt vmcnt(0)
    v_cmp_eq_u32 vcc, s64, v92
    s_nop 1
    s_cmp_eq_u64 vcc, -1
    s_cbranch_scc1 L_gated__pd_32
    s_add_u32 s69, s69, 1
    s_cmp_lt_u32 s69, 0x40000
    s_cbranch_scc0 L_gated__pd_32
    s_sleep 2
    s_branch L_gated__pl_31
L_gated__pd_32:
L_gated__uw_30:
    s_mov_b32 s70, s2
    s_add_u32 s71, s2, 256
    s_add_u32 s72, s2, 512
    s_cmp_lt_u32 s72, 640
    s_cselect_b32 s72, s72, s2
    v_lshlrev_b32 v1, 4, v0
    s_mul_i32 s67, s70, 4224
    s_add_u32 s67, s67, 8388608
    buffer_load_dwordx4 v[100:103], v1, s[20:23], s67 offen offset:0 sc1
    buffer_load_dwordx4 v[104:107], v1, s[20:23], s67 offen offset:1024 sc1
    buffer_load_dwordx4 v[108:111], v1, s[20:23], s67 offen offset:2048 sc1
    buffer_load_dwordx4 v[112:115], v1, s[20:23], s67 offen offset:3072 sc1
    s_mul_i32 s67, s71, 4224
    s_add_u32 s67, s67, 8388608
    buffer_load_dwordx4 v[116:119], v1, s[20:23], s67 offen offset:0 sc1
    buffer_load_dwordx4 v[120:123], v1, s[20:23], s67 offen offset:1024 sc1
    buffer_load_dwordx4 v[124:127], v1, s[20:23], s67 offen offset:2048 sc1
    buffer_load_dwordx4 v[128:131], v1, s[20:23], s67 offen offset:3072 sc1
    s_mul_i32 s67, s72, 4224
    s_add_u32 s67, s67, 8388608
    buffer_load_dwordx4 v[132:135], v1, s[20:23], s67 offen offset:0 sc1
    buffer_load_dwordx4 v[136:139], v1, s[20:23], s67 offen offset:1024 sc1
    buffer_load_dwordx4 v[140:143], v1, s[20:23], s67 offen offset:2048 sc1
    buffer_load_dwordx4 v[144:147], v1, s[20:23], s67 offen offset:3072 sc1
    v_mov_b32 v1, 161684
    v_mov_b32 v2, 3
    ds_write_b32 v1, v2
    s_waitcnt vmcnt(12)
    ds_read_b64_tr_b16 v[160:161], v235 offset:0
    ds_read_b64_tr_b16 v[162:163], v235 offset:2560
    ds_read_b64_tr_b16 v[164:165], v235 offset:8
    ds_read_b64_tr_b16 v[166:167], v235 offset:2568
    ds_read_b64_tr_b16 v[168:169], v235 offset:64
    ds_read_b64_tr_b16 v[170:171], v235 offset:2624
    ds_read_b64_tr_b16 v[172:173], v235 offset:72
    ds_read_b64_tr_b16 v[174:175], v235 offset:2632
    ds_read_b64_tr_b16 v[176:177], v236 offset:128
    ds_read_b64_tr_b16 v[178:179], v236 offset:2688
    s_lshr_b32 s67, s2, 3
    s_and_b32 s68, s2, 7
    s_mul_i32 s68, s68, 48
    s_add_u32 s67, s67, s68
    s_mul_i32 s67, s67, 5120
    s_add_u32 s67, s67, 6291456
    s_add_u32 s68, s67, 4096
    s_waitcnt lgkmcnt(0)
    buffer_store_dwordx4 v[160:163], v237, s[20:23], s67 offen offset:0 sc1
    buffer_store_dwordx4 v[164:167], v237, s[20:23], s67 offen offset:1024 sc1
    buffer_store_dwordx4 v[168:171], v237, s[20:23], s67 offen offset:2048 sc1
    buffer_store_dwordx4 v[172:175], v237, s[20:23], s67 offen offset:3072 sc1
    buffer_store_dwordx4 v[176:179], v237, s[20:23], s68 offen sc1
    s_cmp_ge_u32 s51, 384
    s_cbranch_scc1 L_gated__wb_33
    ds_read_b64_tr_b16 v[180:181], v235 offset:5120
    ds_read_b64_tr_b16 v[182:183], v235 offset:7680
    ds_read_b64_tr_b16 v[184:185], v235 offset:5128
    ds_read_b64_tr_b16 v[186:187], v235 offset:7688
    ds_read_b64_tr_b16 v[188:189], v235 offset:5184
    ds_read_b64_tr_b16 v[190:191], v235 offset:7744
    ds_read_b64_tr_b16 v[192:193], v235 offset:5192
    ds_read_b64_tr_b16 v[194:195], v235 offset:7752
    ds_read_b64_tr_b16 v[196:197], v236 offset:5248
    ds_read_b64_tr_b16 v[198:199], v236 offset:7808
    s_lshr_b32 s67, s51, 3
    s_and_b32 s68, s51, 7
    s_mul_i32 s68, s68, 48
    s_add_u32 s67, s67, s68
    s_mul_i32 s67, s67, 5120
    s_add_u32 s67, s67, 6291456
    s_add_u32 s68, s67, 4096
    s_waitcnt lgkmcnt(0)
    buffer_store_dwordx4 v[180:183], v237, s[20:23], s67 offen offset:0 sc1
    buffer_store_dwordx4 v[184:187], v237, s[20:23], s67 offen offset:1024 sc1
    buffer_store_dwordx4 v[188:191], v237, s[20:23], s67 offen offset:2048 sc1
    buffer_store_dwordx4 v[192:195], v237, s[20:23], s67 offen offset:3072 sc1
    buffer_store_dwordx4 v[196:199], v237, s[20:23], s68 offen sc1
L_gated__wb_33:
    v_and_b32 v1, 15, v0
    v_lshlrev_b32 v1, 4, v1
    global_load_dwordx4 v[8:11], v1, s[58:59] offset:0
    global_load_dwordx4 v[12:15], v1, s[58:59] offset:256
    global_load_dwordx4 v[16:19], v1, s[58:59] offset:512
    global_load_dwordx4 v[20:23], v1, s[58:59] offset:768
    global_load_dwordx4 v[24:27], v1, s[58:59] offset:1024
    v_lshrrev_b32 v2, 4, v0
    s_movk_i32 s67, 1280
    v_mul_lo_u32 v2, v2, s67
    v_add_u32 v2, v2, v1
    s_lshl_b32 s67, s2, 3
    s_mul_i32 s67, s67, 1280
    buffer_load_dwordx4 v[28:31], v2, s[8:11], s67 offen offset:0
    buffer_load_dwordx4 v[32:35], v2, s[8:11], s67 offen offset:256
    buffer_load_dwordx4 v[36:39], v2, s[8:11], s67 offen offset:512
    buffer_load_dwordx4 v[40:43], v2, s[8:11], s67 offen offset:768
    buffer_load_dwordx4 v[44:47], v2, s[8:11], s67 offen offset:1024
    s_add_u32 s67, s67, 5120
    buffer_load_dwordx4 v[48:51], v2, s[8:11], s67 offen offset:0
    buffer_load_dwordx4 v[52:55], v2, s[8:11], s67 offen offset:256
    buffer_load_dwordx4 v[56:59], v2, s[8:11], s67 offen offset:512
    buffer_load_dwordx4 v[60:63], v2, s[8:11], s67 offen offset:768
    buffer_load_dwordx4 v[64:67], v2, s[8:11], s67 offen offset:1024
    s_setprio 2
    s_waitcnt vmcnt(15)
    s_and_b32 s68, s2, 7
    s_lshl_b32 s68, s68, 8
    s_lshr_b32 s69, s2, 3
    s_lshl_b32 s69, s69, 2
    s_add_u32 s69, s69, s68
    s_add_u32 s69, s69, 14766080
    v_mov_b32 v2, s64
    v_mov_b32 v3, 0
    s_mov_b64 exec, 1
    buffer_store_dword v2, v3, s[20:23], s69 offen sc1
    s_mov_b64 exec, -1
    s_cmp_ge_u32 s51, 384
    s_cbranch_scc1 L_gated__wb_34
    s_and_b32 s68, s51, 7
    s_lshl_b32 s68, s68, 8
    s_lshr_b32 s69, s51, 3
    s_lshl_b32 s69, s69, 2
    s_add_u32 s69, s69, s68
    s_add_u32 s69, s69, 14766080
    v_mov_b32 v2, s64
    v_mov_b32 v3, 0
    s_mov_b64 exec, 1
    buffer_store_dword v2, v3, s[20:23], s69 offen sc1
    s_mov_b64 exec, -1
L_gated__wb_34:
    v_mov_b32 v2, 161696
    s_mov_b32 s69, 0
L_gated__ls_35:
    ds_read_b32 v3, v2
    s_waitcnt lgkmcnt(0)
    v_readfirstlane_b32 s78, v3
    s_nop 1
    s_cmp_eq_u32 s78, 4
    s_cbranch_scc1 L_gated__ld_36
    s_add_u32 s69, s69, 1
    s_cmp_lt_u32 s69, 0x400000
    s_cbranch_scc0 L_gated__ld_36
    s_sleep 1
    s_branch L_gated__ls_35
L_gated__ld_36:
    v_mov_b32 v150, 0
    v_mov_b32 v151, 0
    v_mov_b32 v152, 0
    v_mov_b32 v153, 0
    v_lshlrev_b32 v2, 4, v0
    v_cmp_eq_u32 vcc, 0, v0
    ds_write_b128 v2, v[150:153] offset:0
    ds_write_b128 v2, v[150:153] offset:4640
    ds_write_b128 v2, v[150:153] offset:9280
    ds_write_b128 v2, v[150:153] offset:13920
    ds_write_b128 v2, v[150:153] offset:18560
    ds_write_b128 v2, v[150:153] offset:23200
    ds_write_b128 v2, v[150:153] offset:27840
    ds_write_b128 v2, v[150:153] offset:32480
    ds_write_b128 v2, v[150:153] offset:37120
    ds_write_b128 v2, v[150:153] offset:41760
    ds_write_b128 v2, v[150:153] offset:46400
    ds_write_b128 v2, v[150:153] offset:51040
    v_mov_b32_dpp v154, v103 wave_ror:1 row_mask:0xf bank_mask:0xf
    v_mov_b32_dpp v155, v102 wave_ror:1 row_mask:0xf bank_mask:0xf
    v_mov_b32 v161, v100
    v_mov_b32 v162, v101
    v_mov_b32 v163, v102
    v_cndmask_b32 v160, v154, v150, vcc
    v_cndmask_b32 v158, v155, v150, vcc
    ds_write_b128 v2, v[100:103] offset:14304
    v_alignbit_b32 v164, v160, v158, 16
    v_alignbit_b32 v165, v100, v160, 16
    v_alignbit_b32 v166, v101, v100, 16
    v_alignbit_b32 v167, v102, v101, 16
    ds_write_b128 v2, v[160:163] offset:5024
    v_mov_b32 v168, v165
    v_mov_b32 v169, v166
    v_mov_b32 v170, v167
    v_alignbit_b32 v171, v103, v102, 16
    ds_write_b128 v2, v[164:167] offset:384
    ds_write_b128 v2, v[168:171] offset:9664
    v_mov_b32_dpp v156, v107 wave_ror:1 row_mask:0xf bank_mask:0xf
    v_mov_b32_dpp v157, v106 wave_ror:1 row_mask:0xf bank_mask:0xf
    v_mov_b32 v173, v104
    v_mov_b32 v174, v105
    v_mov_b32 v175, v106
    v_cndmask_b32 v172, v156, v154, vcc
    v_cndmask_b32 v158, v157, v155, vcc
    ds_write_b128 v2, v[104:107] offset:15328
    v_alignbit_b32 v176, v172, v158, 16
    v_alignbit_b32 v177, v104, v172, 16
    v_alignbit_b32 v178, v105, v104, 16
    v_alignbit_b32 v179, v106, v105, 16
    ds_write_b128 v2, v[172:175] offset:6048
    v_mov_b32 v180, v177
    v_mov_b32 v181, v178
    v_mov_b32 v182, v179
    v_alignbit_b32 v183, v107, v106, 16
    ds_write_b128 v2, v[176:179] offset:1408
    ds_write_b128 v2, v[180:183] offset:10688
    v_mov_b32_dpp v154, v111 wave_ror:1 row_mask:0xf bank_mask:0xf
    v_mov_b32_dpp v155, v110 wave_ror:1 row_mask:0xf bank_mask:0xf
    v_mov_b32 v161, v108
    v_mov_b32 v162, v109
    v_mov_b32 v163, v110
    v_cndmask_b32 v160, v154, v156, vcc
    v_cndmask_b32 v158, v155, v157, vcc
    ds_write_b128 v2, v[108:111] offset:16352
    v_alignbit_b32 v164, v160, v158, 16
    v_alignbit_b32 v165, v108, v160, 16
    v_alignbit_b32 v166, v109, v108, 16
    v_alignbit_b32 v167, v110, v109, 16
    ds_write_b128 v2, v[160:163] offset:7072
    v_mov_b32 v168, v165
    v_mov_b32 v169, v166
    v_mov_b32 v170, v167
    v_alignbit_b32 v171, v111, v110, 16
    ds_write_b128 v2, v[164:167] offset:2432
    ds_write_b128 v2, v[168:171] offset:11712
    v_mov_b32_dpp v156, v115 wave_ror:1 row_mask:0xf bank_mask:0xf
    v_mov_b32_dpp v157, v114 wave_ror:1 row_mask:0xf bank_mask:0xf
    v_mov_b32 v173, v112
    v_mov_b32 v174, v113
    v_mov_b32 v175, v114
    v_cndmask_b32 v172, v156, v154, vcc
    v_cndmask_b32 v158, v157, v155, vcc
    ds_write_b128 v2, v[112:115] offset:17376
    v_alignbit_b32 v176, v172, v158, 16
    v_alignbit_b32 v177, v112, v172, 16
    v_alignbit_b32 v178, v113, v112, 16
    v_alignbit_b32 v179, v114, v113, 16
    ds_write_b128 v2, v[172:175] offset:8096
    v_mov_b32 v180, v177
    v_mov_b32 v181, v178
    v_mov_b32 v182, v179
    v_alignbit_b32 v183, v115, v114, 16
    ds_write_b128 v2, v[176:179] offset:3456
    ds_write_b128 v2, v[180:183] offset:12736
    v_mov_b32_dpp v154, v119 wave_ror:1 row_mask:0xf bank_mask:0xf
    v_mov_b32_dpp v155, v118 wave_ror:1 row_mask:0xf bank_mask:0xf
    v_mov_b32 v161, v116
    v_mov_b32 v162, v117
    v_mov_b32 v163, v118
    v_cndmask_b32 v160, v154, v150, vcc
    v_cndmask_b32 v158, v155, v150, vcc
    ds_write_b128 v2, v[116:119] offset:32864
    v_alignbit_b32 v164, v160, v158, 16
    v_alignbit_b32 v165, v116, v160, 16
    v_alignbit_b32 v166, v117, v116, 16
    v_alignbit_b32 v167, v118, v117, 16
    ds_write_b128 v2, v[160:163] offset:23584
    v_mov_b32 v168, v165
    v_mov_b32 v169, v166
    v_mov_b32 v170, v167
    v_alignbit_b32 v171, v119, v118, 16
    ds_write_b128 v2, v[164:167] offset:18944
    ds_write_b128 v2, v[168:171] offset:28224
    v_mov_b32_dpp v156, v123 wave_ror:1 row_mask:0xf bank_mask:0xf
    v_mov_b32_dpp v157, v122 wave_ror:1 row_mask:0xf bank_mask:0xf
    v_mov_b32 v173, v120
    v_mov_b32 v174, v121
    v_mov_b32 v175, v122
    v_cndmask_b32 v172, v156, v154, vcc
    v_cndmask_b32 v158, v157, v155, vcc
    ds_write_b128 v2, v[120:123] offset:33888
    v_alignbit_b32 v176, v172, v158, 16
    v_alignbit_b32 v177, v120, v172, 16
    v_alignbit_b32 v178, v121, v120, 16
    v_alignbit_b32 v179, v122, v121, 16
    ds_write_b128 v2, v[172:175] offset:24608
    v_mov_b32 v180, v177
    v_mov_b32 v181, v178
    v_mov_b32 v182, v179
    v_alignbit_b32 v183, v123, v122, 16
    ds_write_b128 v2, v[176:179] offset:19968
    ds_write_b128 v2, v[180:183] offset:29248
    v_mov_b32_dpp v154, v127 wave_ror:1 row_mask:0xf bank_mask:0xf
    v_mov_b32_dpp v155, v126 wave_ror:1 row_mask:0xf bank_mask:0xf
    v_mov_b32 v161, v124
    v_mov_b32 v162, v125
    v_mov_b32 v163, v126
    v_cndmask_b32 v160, v154, v156, vcc
    v_cndmask_b32 v158, v155, v157, vcc
    ds_write_b128 v2, v[124:127] offset:34912
    v_alignbit_b32 v164, v160, v158, 16
    v_alignbit_b32 v165, v124, v160, 16
    v_alignbit_b32 v166, v125, v124, 16
    v_alignbit_b32 v167, v126, v125, 16
    ds_write_b128 v2, v[160:163] offset:25632
    v_mov_b32 v168, v165
    v_mov_b32 v169, v166
    v_mov_b32 v170, v167
    v_alignbit_b32 v171, v127, v126, 16
    ds_write_b128 v2, v[164:167] offset:20992
    ds_write_b128 v2, v[168:171] offset:30272
    v_mov_b32_dpp v156, v131 wave_ror:1 row_mask:0xf bank_mask:0xf
    v_mov_b32_dpp v157, v130 wave_ror:1 row_mask:0xf bank_mask:0xf
    v_mov_b32 v173, v128
    v_mov_b32 v174, v129
    v_mov_b32 v175, v130
    v_cndmask_b32 v172, v156, v154, vcc
    v_cndmask_b32 v158, v157, v155, vcc
    ds_write_b128 v2, v[128:131] offset:35936
    v_alignbit_b32 v176, v172, v158, 16
    v_alignbit_b32 v177, v128, v172, 16
    v_alignbit_b32 v178, v129, v128, 16
    v_alignbit_b32 v179, v130, v129, 16
    ds_write_b128 v2, v[172:175] offset:26656
    v_mov_b32 v180, v177
    v_mov_b32 v181, v178
    v_mov_b32 v182, v179
    v_alignbit_b32 v183, v131, v130, 16
    ds_write_b128 v2, v[176:179] offset:22016
    ds_write_b128 v2, v[180:183] offset:31296
    v_mov_b32_dpp v154, v135 wave_ror:1 row_mask:0xf bank_mask:0xf
    v_mov_b32_dpp v155, v134 wave_ror:1 row_mask:0xf bank_mask:0xf
    v_mov_b32 v161, v132
    v_mov_b32 v162, v133
    v_mov_b32 v163, v134
    v_cndmask_b32 v160, v154, v150, vcc
    v_cndmask_b32 v158, v155, v150, vcc
    ds_write_b128 v2, v[132:135] offset:51424
    v_alignbit_b32 v164, v160, v158, 16
    v_alignbit_b32 v165, v132, v160, 16
    v_alignbit_b32 v166, v133, v132, 16
    v_alignbit_b32 v167, v134, v133, 16
    ds_write_b128 v2, v[160:163] offset:42144
    v_mov_b32 v168, v165
    v_mov_b32 v169, v166
    v_mov_b32 v170, v167
    v_alignbit_b32 v171, v135, v134, 16
    ds_write_b128 v2, v[164:167] offset:37504
    ds_write_b128 v2, v[168:171] offset:46784
    v_mov_b32_dpp v156, v139 wave_ror:1 row_mask:0xf bank_mask:0xf
    v_mov_b32_dpp v157, v138 wave_ror:1 row_mask:0xf bank_mask:0xf
    v_mov_b32 v173, v136
    v_mov_b32 v174, v137
    v_mov_b32 v175, v138
    v_cndmask_b32 v172, v156, v154, vcc
    v_cndmask_b32 v158, v157, v155, vcc
    ds_write_b128 v2, v[136:139] offset:52448
    v_alignbit_b32 v176, v172, v158, 16
    v_alignbit_b32 v177, v136, v172, 16
    v_alignbit_b32 v178, v137, v136, 16
    v_alignbit_b32 v179, v138, v137, 16
    ds_write_b128 v2, v[172:175] offset:43168
    v_mov_b32 v180, v177
    v_mov_b32 v181, v178
    v_mov_b32 v182, v179
    v_alignbit_b32 v183, v139, v138, 16
    ds_write_b128 v2, v[176:179] offset:38528
    ds_write_b128 v2, v[180:183] offset:47808
    v_mov_b32_dpp v154, v143 wave_ror:1 row_mask:0xf bank_mask:0xf
    v_mov_b32_dpp v155, v142 wave_ror:1 row_mask:0xf bank_mask:0xf
    v_mov_b32 v161, v140
    v_mov_b32 v162, v141
    v_mov_b32 v163, v142
    v_cndmask_b32 v160, v154, v156, vcc
    v_cndmask_b32 v158, v155, v157, vcc
    ds_write_b128 v2, v[140:143] offset:53472
    v_alignbit_b32 v164, v160, v158, 16
    v_alignbit_b32 v165, v140, v160, 16
    v_alignbit_b32 v166, v141, v140, 16
    v_alignbit_b32 v167, v142, v141, 16
    ds_write_b128 v2, v[160:163] offset:44192
    v_mov_b32 v168, v165
    v_mov_b32 v169, v166
    v_mov_b32 v170, v167
    v_alignbit_b32 v171, v143, v142, 16
    ds_write_b128 v2, v[164:167] offset:39552
    ds_write_b128 v2, v[168:171] offset:48832
    v_mov_b32_dpp v156, v147 wave_ror:1 row_mask:0xf bank_mask:0xf
    v_mov_b32_dpp v157, v146 wave_ror:1 row_mask:0xf bank_mask:0xf
    v_mov_b32 v173, v144
    v_mov_b32 v174, v145
    v_mov_b32 v175, v146
    v_cndmask_b32 v172, v156, v154, vcc
    v_cndmask_b32 v158, v157, v155, vcc
    ds_write_b128 v2, v[144:147] offset:54496
    v_alignbit_b32 v176, v172, v158, 16
    v_alignbit_b32 v177, v144, v172, 16
    v_alignbit_b32 v178, v145, v144, 16
    v_alignbit_b32 v179, v146, v145, 16
    ds_write_b128 v2, v[172:175] offset:45216
    v_mov_b32 v180, v177
    v_mov_b32 v181, v178
    v_mov_b32 v182, v179
    v_alignbit_b32 v183, v147, v146, 16
    ds_write_b128 v2, v[176:179] offset:40576
    ds_write_b128 v2, v[180:183] offset:49856
    s_waitcnt lgkmcnt(0)
    v_mov_b32 v1, 161692
    v_mov_b32 v2, 1
    ds_write_b32 v1, v2
    s_setprio 0
    s_waitcnt vmcnt(0)
    v_mov_b32 v68, 0
    v_mov_b32 v69, 0
    v_mov_b32 v70, 0
    v_mov_b32 v71, 0
    v_dot2_f32_bf16 v68, v28, v8, v68
    v_dot2_f32_bf16 v69, v48, v8, v69
    v_dot2_f32_bf16 v70, v29, v9, v70
    v_dot2_f32_bf16 v71, v49, v9, v71
    v_dot2_f32_bf16 v68, v30, v10, v68
    v_dot2_f32_bf16 v69, v50, v10, v69
    v_dot2_f32_bf16 v70, v31, v11, v70
    v_dot2_f32_bf16 v71, v51, v11, v71
    v_dot2_f32_bf16 v68, v32, v12, v68
    v_dot2_f32_bf16 v69, v52, v12, v69
    v_dot2_f32_bf16 v70, v33, v13, v70
    v_dot2_f32_bf16 v71, v53, v13, v71
    v_dot2_f32_bf16 v68, v34, v14, v68
    v_dot2_f32_bf16 v69, v54, v14, v69
    v_dot2_f32_bf16 v70, v35, v15, v70
    v_dot2_f32_bf16 v71, v55, v15, v71
    v_dot2_f32_bf16 v68, v36, v16, v68
    v_dot2_f32_bf16 v69, v56, v16, v69
    v_dot2_f32_bf16 v70, v37, v17, v70
    v_dot2_f32_bf16 v71, v57, v17, v71
    v_dot2_f32_bf16 v68, v38, v18, v68
    v_dot2_f32_bf16 v69, v58, v18, v69
    v_dot2_f32_bf16 v70, v39, v19, v70
    v_dot2_f32_bf16 v71, v59, v19, v71
    v_dot2_f32_bf16 v68, v40, v20, v68
    v_dot2_f32_bf16 v69, v60, v20, v69
    v_dot2_f32_bf16 v70, v41, v21, v70
    v_dot2_f32_bf16 v71, v61, v21, v71
    v_dot2_f32_bf16 v68, v42, v22, v68
    v_dot2_f32_bf16 v69, v62, v22, v69
    v_dot2_f32_bf16 v70, v43, v23, v70
    v_dot2_f32_bf16 v71, v63, v23, v71
    v_dot2_f32_bf16 v68, v44, v24, v68
    v_dot2_f32_bf16 v69, v64, v24, v69
    v_dot2_f32_bf16 v70, v45, v25, v70
    v_dot2_f32_bf16 v71, v65, v25, v71
    v_dot2_f32_bf16 v68, v46, v26, v68
    v_dot2_f32_bf16 v69, v66, v26, v69
    v_dot2_f32_bf16 v70, v47, v27, v70
    v_dot2_f32_bf16 v71, v67, v27, v71
    s_nop 2
    v_add_f32 v68, v68, v70
    v_add_f32 v69, v69, v71
    s_nop 0
    v_add_f32_dpp v68, v68, v68 row_shr:1 row_mask:0xf bank_mask:0xf bound_ctrl:1
    v_add_f32_dpp v69, v69, v69 row_shr:1 row_mask:0xf bank_mask:0xf bound_ctrl:1
    s_nop 0
    v_add_f32_dpp v68, v68, v68 row_shr:2 row_mask:0xf bank_mask:0xf bound_ctrl:1
    v_add_f32_dpp v69, v69, v69 row_shr:2 row_mask:0xf bank_mask:0xf bound_ctrl:1
    s_nop 0
    v_add_f32_dpp v68, v68, v68 row_shr:4 row_mask:0xf bank_mask:0xf bound_ctrl:1
    v_add_f32_dpp v69, v69, v69 row_shr:4 row_mask:0xf bank_mask:0xf bound_ctrl:1
    s_nop 0
    v_add_f32_dpp v68, v68, v68 row_shr:8 row_mask:0xf bank_mask:0xf bound_ctrl:1
    v_add_f32_dpp v69, v69, v69 row_shr:8 row_mask:0xf bank_mask:0xf bound_ctrl:1
    s_nop 0
    v_mul_f32 v68, 0xbfb8aa3b, v68
    v_mul_f32 v69, 0xbfb8aa3b, v69
    v_exp_f32 v68, v68
    v_exp_f32 v69, v69
    s_nop 0
    v_add_f32 v68, 1.0, v68
    v_add_f32 v69, 1.0, v69
    v_rcp_f32 v68, v68
    v_rcp_f32 v69, v69
    s_lshl_b32 s67, s2, 5
    s_add_u32 s67, s67, 14680064
    v_lshrrev_b32 v1, 4, v0
    v_lshlrev_b32 v1, 2, v1
    s_mov_b32 exec_lo, 0x80008000
    s_mov_b32 exec_hi, 0x80008000
    buffer_store_dword v68, v1, s[20:23], s67 offen sc1
    buffer_store_dword v69, v1, s[20:23], s67 offen offset:16 sc1
    s_mov_b64 exec, -1
    s_waitcnt vmcnt(0)
    s_lshl_b32 s69, s2, 2
    s_add_u32 s69, s69, 14761984
    v_mov_b32 v2, s64
    v_mov_b32 v3, 0
    s_mov_b64 exec, 1
    buffer_store_dword v2, v3, s[20:23], s69 offen sc1
    s_mov_b64 exec, -1
gated_mix__ssm_conv_s4__swiglu_ffn__prompt_kernel_p1done:
    s_sub_u32 s66, s3, 4
    s_lshl_b32 s50, s66, 8
    s_add_u32 s50, s50, s2
    s_cmp_ge_u32 s66, 3
    s_cbranch_scc1 gated_mix__ssm_conv_s4__swiglu_ffn__prompt_kernel_ssm_done
    s_cmp_lt_u32 s50, 640
    s_cbranch_scc1 L_gated__nch_37
    s_branch gated_mix__ssm_conv_s4__swiglu_ffn__prompt_kernel_ssm_done
L_gated__nch_37:
    s_waitcnt vmcnt(0)
    s_setprio 2
    v_lshlrev_b32 v206, 16, v206
    v_lshlrev_b32 v207, 16, v207
    v_lshlrev_b32 v208, 16, v208
    v_lshlrev_b32 v209, 16, v209
    v_lshlrev_b32 v210, 16, v210
    v_lshlrev_b32 v211, 16, v211
    v_mul_f32 v6, v218, v206
    v_mul_f32 v7, v218, v207
    v_mul_f32 v6, 0x3fb8aa3b, v6
    v_mul_f32 v7, 0.15915494, v7
    v_mul_f32 v8, v218, v208
    v_mul_f32 v9, v218, v209
    v_pk_mul_f32 v[30:31], v[210:211], v[8:9] op_sel:[0,0] op_sel_hi:[0,1]
    v_pk_fma_f32 v[24:25], v[210:211], v[8:9], v[30:31] op_sel:[1,1,0] op_sel_hi:[1,0,1] neg_lo:[1,0,0]
    v_exp_f32 v32, v6
    v_fract_f32 v34, v7
    v_cos_f32 v10, v34
    v_sin_f32 v11, v34
    s_nop 0
    v_mul_f32 v10, v10, v32
    v_mul_f32 v11, v11, v32
    v_mul_f32 v32, 0x41800000, v6
    v_mul_f32 v34, 0x41800000, v7
    v_exp_f32 v32, v32
    v_fract_f32 v34, v34
    v_cos_f32 v12, v34
    v_sin_f32 v13, v34
    s_nop 0
    v_mul_f32 v12, v12, v32
    v_mul_f32 v13, v13, v32
    v_mul_f32 v32, 0x43800000, v6
    v_mul_f32 v34, 0x43800000, v7
    v_exp_f32 v32, v32
    v_fract_f32 v34, v34
    v_cos_f32 v14, v34
    v_sin_f32 v15, v34
    s_nop 0
    v_mul_f32 v14, v14, v32
    v_mul_f32 v15, v15, v32
    v_mov_b32 v26, v24
    v_mov_b32 v28, 1.0
    v_mov_b32 v27, v25
    v_mov_b32 v29, 0
    v_cvt_pk_bf16_f32 v66, v26, v27
    v_cvt_pk_bf16_f32 v70, v28, -v29
    ds_write_addtid_b32 v66 offset:0
    ds_write_addtid_b32 v70 offset:4352
    v_pk_mul_f32 v[30:31], v[26:27], v[12:13] op_sel:[0,0] op_sel_hi:[0,1]
    v_mov_b32 v28, v10
    v_pk_fma_f32 v[26:27], v[26:27], v[12:13], v[30:31] op_sel:[1,1,0] op_sel_hi:[1,0,1] neg_lo:[1,0,0]
    v_mov_b32 v29, v11
    v_cvt_pk_bf16_f32 v67, v26, v27
    v_cvt_pk_bf16_f32 v71, v28, -v29
    ds_write_addtid_b32 v67 offset:272
    ds_write_addtid_b32 v71 offset:4624
    v_pk_mul_f32 v[30:31], v[26:27], v[12:13] op_sel:[0,0] op_sel_hi:[0,1]
    v_pk_mul_f32 v[32:33], v[28:29], v[10:11] op_sel:[0,0] op_sel_hi:[0,1]
    v_pk_fma_f32 v[26:27], v[26:27], v[12:13], v[30:31] op_sel:[1,1,0] op_sel_hi:[1,0,1] neg_lo:[1,0,0]
    v_pk_fma_f32 v[36:37], v[28:29], v[10:11], v[32:33] op_sel:[1,1,0] op_sel_hi:[1,0,1] neg_lo:[1,0,0]
    v_cvt_pk_bf16_f32 v68, v26, v27
    v_cvt_pk_bf16_f32 v72, v36, -v37
    ds_write_addtid_b32 v68 offset:544
    ds_write_addtid_b32 v72 offset:4896
    v_pk_mul_f32 v[30:31], v[26:27], v[12:13] op_sel:[0,0] op_sel_hi:[0,1]
    v_pk_mul_f32 v[32:33], v[36:37], v[10:11] op_sel:[0,0] op_sel_hi:[0,1]
    v_pk_fma_f32 v[26:27], v[26:27], v[12:13], v[30:31] op_sel:[1,1,0] op_sel_hi:[1,0,1] neg_lo:[1,0,0]
    v_pk_fma_f32 v[28:29], v[36:37], v[10:11], v[32:33] op_sel:[1,1,0] op_sel_hi:[1,0,1] neg_lo:[1,0,0]
    v_cvt_pk_bf16_f32 v69, v26, v27
    v_cvt_pk_bf16_f32 v73, v28, -v29
    ds_write_addtid_b32 v69 offset:816
    ds_write_addtid_b32 v73 offset:5168
    v_pk_mul_f32 v[30:31], v[26:27], v[12:13] op_sel:[0,0] op_sel_hi:[0,1]
    v_pk_mul_f32 v[32:33], v[28:29], v[10:11] op_sel:[0,0] op_sel_hi:[0,1]
    v_pk_fma_f32 v[26:27], v[26:27], v[12:13], v[30:31] op_sel:[1,1,0] op_sel_hi:[1,0,1] neg_lo:[1,0,0]
    v_pk_fma_f32 v[38:39], v[28:29], v[10:11], v[32:33] op_sel:[1,1,0] op_sel_hi:[1,0,1] neg_lo:[1,0,0]
    v_cvt_pk_bf16_f32 v66, v26, v27
    v_cvt_pk_bf16_f32 v70, v38, -v39
    ds_write_addtid_b32 v66 offset:1088
    ds_write_addtid_b32 v70 offset:5440
    v_pk_mul_f32 v[30:31], v[26:27], v[12:13] op_sel:[0,0] op_sel_hi:[0,1]
    v_pk_mul_f32 v[32:33], v[38:39], v[10:11] op_sel:[0,0] op_sel_hi:[0,1]
    v_pk_fma_f32 v[26:27], v[26:27], v[12:13], v[30:31] op_sel:[1,1,0] op_sel_hi:[1,0,1] neg_lo:[1,0,0]
    v_pk_fma_f32 v[28:29], v[38:39], v[10:11], v[32:33] op_sel:[1,1,0] op_sel_hi:[1,0,1] neg_lo:[1,0,0]
    v_cvt_pk_bf16_f32 v67, v26, v27
    v_cvt_pk_bf16_f32 v71, v28, -v29
    ds_write_addtid_b32 v67 offset:1360
    ds_write_addtid_b32 v71 offset:5712
    v_pk_mul_f32 v[30:31], v[26:27], v[12:13] op_sel:[0,0] op_sel_hi:[0,1]
    v_pk_mul_f32 v[32:33], v[28:29], v[10:11] op_sel:[0,0] op_sel_hi:[0,1]
    v_pk_fma_f32 v[26:27], v[26:27], v[12:13], v[30:31] op_sel:[1,1,0] op_sel_hi:[1,0,1] neg_lo:[1,0,0]
    v_pk_fma_f32 v[40:41], v[28:29], v[10:11], v[32:33] op_sel:[1,1,0] op_sel_hi:[1,0,1] neg_lo:[1,0,0]
    v_cvt_pk_bf16_f32 v68, v26, v27
    v_cvt_pk_bf16_f32 v72, v40, -v41
    ds_write_addtid_b32 v68 offset:1632
    ds_write_addtid_b32 v72 offset:5984
    v_pk_mul_f32 v[30:31], v[26:27], v[12:13] op_sel:[0,0] op_sel_hi:[0,1]
    v_pk_mul_f32 v[32:33], v[40:41], v[10:11] op_sel:[0,0] op_sel_hi:[0,1]
    v_pk_fma_f32 v[26:27], v[26:27], v[12:13], v[30:31] op_sel:[1,1,0] op_sel_hi:[1,0,1] neg_lo:[1,0,0]
    v_pk_fma_f32 v[28:29], v[40:41], v[10:11], v[32:33] op_sel:[1,1,0] op_sel_hi:[1,0,1] neg_lo:[1,0,0]
    v_cvt_pk_bf16_f32 v69, v26, v27
    v_cvt_pk_bf16_f32 v73, v28, -v29
    ds_write_addtid_b32 v69 offset:1904
    ds_write_addtid_b32 v73 offset:6256
    v_pk_mul_f32 v[30:31], v[26:27], v[12:13] op_sel:[0,0] op_sel_hi:[0,1]
    v_pk_mul_f32 v[32:33], v[28:29], v[10:11] op_sel:[0,0] op_sel_hi:[0,1]
    v_pk_fma_f32 v[26:27], v[26:27], v[12:13], v[30:31] op_sel:[1,1,0] op_sel_hi:[1,0,1] neg_lo:[1,0,0]
    v_pk_fma_f32 v[42:43], v[28:29], v[10:11], v[32:33] op_sel:[1,1,0] op_sel_hi:[1,0,1] neg_lo:[1,0,0]
    v_cvt_pk_bf16_f32 v66, v26, v27
    v_cvt_pk_bf16_f32 v70, v42, -v43
    ds_write_addtid_b32 v66 offset:2176
    ds_write_addtid_b32 v70 offset:6528
    v_pk_mul_f32 v[30:31], v[26:27], v[12:13] op_sel:[0,0] op_sel_hi:[0,1]
    v_pk_mul_f32 v[32:33], v[42:43], v[10:11] op_sel:[0,0] op_sel_hi:[0,1]
    v_pk_fma_f32 v[26:27], v[26:27], v[12:13], v[30:31] op_sel:[1,1,0] op_sel_hi:[1,0,1] neg_lo:[1,0,0]
    v_pk_fma_f32 v[28:29], v[42:43], v[10:11], v[32:33] op_sel:[1,1,0] op_sel_hi:[1,0,1] neg_lo:[1,0,0]
    v_cvt_pk_bf16_f32 v67, v26, v27
    v_cvt_pk_bf16_f32 v71, v28, -v29
    ds_write_addtid_b32 v67 offset:2448
    ds_write_addtid_b32 v71 offset:6800
    v_pk_mul_f32 v[30:31], v[26:27], v[12:13] op_sel:[0,0] op_sel_hi:[0,1]
    v_pk_mul_f32 v[32:33], v[28:29], v[10:11] op_sel:[0,0] op_sel_hi:[0,1]
    v_pk_fma_f32 v[26:27], v[26:27], v[12:13], v[30:31] op_sel:[1,1,0] op_sel_hi:[1,0,1] neg_lo:[1,0,0]
    v_pk_fma_f32 v[44:45], v[28:29], v[10:11], v[32:33] op_sel:[1,1,0] op_sel_hi:[1,0,1] neg_lo:[1,0,0]
    v_cvt_pk_bf16_f32 v68, v26, v27
    v_cvt_pk_bf16_f32 v72, v44, -v45
    ds_write_addtid_b32 v68 offset:2720
    ds_write_addtid_b32 v72 offset:7072
    v_pk_mul_f32 v[30:31], v[26:27], v[12:13] op_sel:[0,0] op_sel_hi:[0,1]
    v_pk_mul_f32 v[32:33], v[44:45], v[10:11] op_sel:[0,0] op_sel_hi:[0,1]
    v_pk_fma_f32 v[26:27], v[26:27], v[12:13], v[30:31] op_sel:[1,1,0] op_sel_hi:[1,0,1] neg_lo:[1,0,0]
    v_pk_fma_f32 v[28:29], v[44:45], v[10:11], v[32:33] op_sel:[1,1,0] op_sel_hi:[1,0,1] neg_lo:[1,0,0]
    v_cvt_pk_bf16_f32 v69, v26, v27
    v_cvt_pk_bf16_f32 v73, v28, -v29
    ds_write_addtid_b32 v69 offset:2992
    ds_write_addtid_b32 v73 offset:7344
    v_pk_mul_f32 v[30:31], v[26:27], v[12:13] op_sel:[0,0] op_sel_hi:[0,1]
    v_pk_mul_f32 v[32:33], v[28:29], v[10:11] op_sel:[0,0] op_sel_hi:[0,1]
    v_pk_fma_f32 v[26:27], v[26:27], v[12:13], v[30:31] op_sel:[1,1,0] op_sel_hi:[1,0,1] neg_lo:[1,0,0]
    v_pk_fma_f32 v[46:47], v[28:29], v[10:11], v[32:33] op_sel:[1,1,0] op_sel_hi:[1,0,1] neg_lo:[1,0,0]
    v_cvt_pk_bf16_f32 v66, v26, v27
    v_cvt_pk_bf16_f32 v70, v46, -v47
    ds_write_addtid_b32 v66 offset:3264
    ds_write_addtid_b32 v70 offset:7616
    v_pk_mul_f32 v[30:31], v[26:27], v[12:13] op_sel:[0,0] op_sel_hi:[0,1]
    v_pk_mul_f32 v[32:33], v[46:47], v[10:11] op_sel:[0,0] op_sel_hi:[0,1]
    v_pk_fma_f32 v[26:27], v[26:27], v[12:13], v[30:31] op_sel:[1,1,0] op_sel_hi:[1,0,1] neg_lo:[1,0,0]
    v_pk_fma_f32 v[28:29], v[46:47], v[10:11], v[32:33] op_sel:[1,1,0] op_sel_hi:[1,0,1] neg_lo:[1,0,0]
    v_cvt_pk_bf16_f32 v67, v26, v27
    v_cvt_pk_bf16_f32 v71, v28, -v29
    ds_write_addtid_b32 v67 offset:3536
    ds_write_addtid_b32 v71 offset:7888
    v_pk_mul_f32 v[30:31], v[26:27], v[12:13] op_sel:[0,0] op_sel_hi:[0,1]
    v_pk_mul_f32 v[32:33], v[28:29], v[10:11] op_sel:[0,0] op_sel_hi:[0,1]
    v_pk_fma_f32 v[26:27], v[26:27], v[12:13], v[30:31] op_sel:[1,1,0] op_sel_hi:[1,0,1] neg_lo:[1,0,0]
    v_pk_fma_f32 v[48:49], v[28:29], v[10:11], v[32:33] op_sel:[1,1,0] op_sel_hi:[1,0,1] neg_lo:[1,0,0]
    v_cvt_pk_bf16_f32 v68, v26, v27
    v_cvt_pk_bf16_f32 v72, v48, -v49
    ds_write_addtid_b32 v68 offset:3808
    ds_write_addtid_b32 v72 offset:8160
    v_pk_mul_f32 v[30:31], v[26:27], v[12:13] op_sel:[0,0] op_sel_hi:[0,1]
    v_pk_mul_f32 v[32:33], v[48:49], v[10:11] op_sel:[0,0] op_sel_hi:[0,1]
    v_pk_fma_f32 v[26:27], v[26:27], v[12:13], v[30:31] op_sel:[1,1,0] op_sel_hi:[1,0,1] neg_lo:[1,0,0]
    v_pk_fma_f32 v[28:29], v[48:49], v[10:11], v[32:33] op_sel:[1,1,0] op_sel_hi:[1,0,1] neg_lo:[1,0,0]
    v_cvt_pk_bf16_f32 v69, v26, v27
    v_cvt_pk_bf16_f32 v73, v28, -v29
    ds_write_addtid_b32 v69 offset:4080
    ds_write_addtid_b32 v73 offset:8432
    v_pk_mul_f32 v[30:31], v[14:15], v[14:15] op_sel:[0,0] op_sel_hi:[0,1]
    v_pk_fma_f32 v[16:17], v[14:15], v[14:15], v[30:31] op_sel:[1,1,0] op_sel_hi:[1,0,1] neg_lo:[1,0,0]
    ds_read_b64 v[76:77], v3 offset:0
    ds_read_b64 v[78:79], v2 offset:0
    ds_read_b64 v[80:81], v3 offset:16
    ds_read_b64 v[82:83], v2 offset:16
    ds_read_b64 v[84:85], v3 offset:32
    ds_read_b64 v[86:87], v2 offset:32
    ds_read_b64 v[88:89], v3 offset:48
    ds_read_b64 v[90:91], v2 offset:48
    ds_read_b64 v[92:93], v3 offset:4352
    ds_read_b64 v[94:95], v2 offset:4352
    ds_read_b64 v[96:97], v3 offset:4368
    ds_read_b64 v[98:99], v2 offset:4368
    ds_read_b64 v[100:101], v3 offset:4384
    ds_read_b64 v[102:103], v2 offset:4384
    ds_read_b64 v[104:105], v3 offset:4400
    ds_read_b64 v[106:107], v2 offset:4400
    v_pk_mul_f32 v[30:31], v[16:17], v[14:15] op_sel:[0,0] op_sel_hi:[0,1]
    v_pk_mul_f32 v[32:33], v[16:17], v[16:17] op_sel:[0,0] op_sel_hi:[0,1]
    v_pk_fma_f32 v[18:19], v[16:17], v[14:15], v[30:31] op_sel:[1,1,0] op_sel_hi:[1,0,1] neg_lo:[1,0,0]
    v_pk_fma_f32 v[20:21], v[16:17], v[16:17], v[32:33] op_sel:[1,1,0] op_sel_hi:[1,0,1] neg_lo:[1,0,0]
    v_pk_mul_f32 v[30:31], v[36:37], v[14:15] op_sel:[0,0] op_sel_hi:[0,1]
    v_pk_mul_f32 v[32:33], v[38:39], v[14:15] op_sel:[0,0] op_sel_hi:[0,1]
    v_pk_fma_f32 v[50:51], v[36:37], v[14:15], v[30:31] op_sel:[1,1,0] op_sel_hi:[1,0,1] neg_lo:[1,0,0]
    v_pk_fma_f32 v[52:53], v[38:39], v[14:15], v[32:33] op_sel:[1,1,0] op_sel_hi:[1,0,1] neg_lo:[1,0,0]
    v_pk_mul_f32 v[30:31], v[40:41], v[14:15] op_sel:[0,0] op_sel_hi:[0,1]
    v_pk_mul_f32 v[32:33], v[42:43], v[14:15] op_sel:[0,0] op_sel_hi:[0,1]
    v_pk_fma_f32 v[54:55], v[40:41], v[14:15], v[30:31] op_sel:[1,1,0] op_sel_hi:[1,0,1] neg_lo:[1,0,0]
    v_pk_fma_f32 v[56:57], v[42:43], v[14:15], v[32:33] op_sel:[1,1,0] op_sel_hi:[1,0,1] neg_lo:[1,0,0]
    v_pk_mul_f32 v[30:31], v[44:45], v[14:15] op_sel:[0,0] op_sel_hi:[0,1]
    v_pk_mul_f32 v[32:33], v[46:47], v[14:15] op_sel:[0,0] op_sel_hi:[0,1]
    v_pk_fma_f32 v[58:59], v[44:45], v[14:15], v[30:31] op_sel:[1,1,0] op_sel_hi:[1,0,1] neg_lo:[1,0,0]
    v_pk_fma_f32 v[60:61], v[46:47], v[14:15], v[32:33] op_sel:[1,1,0] op_sel_hi:[1,0,1] neg_lo:[1,0,0]
    v_pk_mul_f32 v[30:31], v[48:49], v[14:15] op_sel:[0,0] op_sel_hi:[0,1]
    v_pk_fma_f32 v[62:63], v[48:49], v[14:15], v[30:31] op_sel:[1,1,0] op_sel_hi:[1,0,1] neg_lo:[1,0,0]
    s_waitcnt lgkmcnt(0)
    v_mfma_f32_16x16x32_bf16 v[108:111], v[92:95], v[76:79], v[108:111]
    v_cvt_pk_bf16_f32 v66, v14, -v15
    ds_write_addtid_b32 v66 offset:4352
    v_cvt_pk_bf16_f32 v67, v50, -v51
    ds_write_addtid_b32 v67 offset:4624
    v_mfma_f32_16x16x32_bf16 v[108:111], v[96:99], v[80:83], v[108:111]
    v_cvt_pk_bf16_f32 v68, v52, -v53
    ds_write_addtid_b32 v68 offset:4896
    v_cvt_pk_bf16_f32 v69, v54, -v55
    ds_write_addtid_b32 v69 offset:5168
    v_mfma_f32_16x16x32_bf16 v[108:111], v[100:103], v[84:87], v[108:111]
    v_cvt_pk_bf16_f32 v66, v56, -v57
    ds_write_addtid_b32 v66 offset:5440
    v_cvt_pk_bf16_f32 v67, v58, -v59
    ds_write_addtid_b32 v67 offset:5712
    v_mfma_f32_16x16x32_bf16 v[108:111], v[104:107], v[88:91], v[108:111]
    v_cvt_pk_bf16_f32 v68, v60, -v61
    ds_write_addtid_b32 v68 offset:5984
    v_cvt_pk_bf16_f32 v69, v62, -v63
    ds_write_addtid_b32 v69 offset:6256
    v_cvt_pk_bf16_f32 v66, v16, -v17
    v_cvt_pk_bf16_f32 v70, v18, -v19
    ds_write_addtid_b32 v66 offset:6528
    ds_write_addtid_b32 v70 offset:7616
    v_pk_mul_f32 v[30:31], v[38:39], v[16:17] op_sel:[0,0] op_sel_hi:[0,1]
    v_pk_mul_f32 v[32:33], v[38:39], v[18:19] op_sel:[0,0] op_sel_hi:[0,1]
    v_pk_fma_f32 v[50:51], v[38:39], v[16:17], v[30:31] op_sel:[1,1,0] op_sel_hi:[1,0,1] neg_lo:[1,0,0]
    v_pk_fma_f32 v[52:53], v[38:39], v[18:19], v[32:33] op_sel:[1,1,0] op_sel_hi:[1,0,1] neg_lo:[1,0,0]
    v_cvt_pk_bf16_f32 v67, v50, -v51
    v_cvt_pk_bf16_f32 v71, v52, -v53
    ds_write_addtid_b32 v67 offset:6800
    ds_write_addtid_b32 v71 offset:7888
    v_pk_mul_f32 v[30:31], v[42:43], v[16:17] op_sel:[0,0] op_sel_hi:[0,1]
    v_pk_mul_f32 v[32:33], v[42:43], v[18:19] op_sel:[0,0] op_sel_hi:[0,1]
    v_pk_fma_f32 v[50:51], v[42:43], v[16:17], v[30:31] op_sel:[1,1,0] op_sel_hi:[1,0,1] neg_lo:[1,0,0]
    v_pk_fma_f32 v[52:53], v[42:43], v[18:19], v[32:33] op_sel:[1,1,0] op_sel_hi:[1,0,1] neg_lo:[1,0,0]
    v_cvt_pk_bf16_f32 v68, v50, -v51
    v_cvt_pk_bf16_f32 v72, v52, -v53
    ds_write_addtid_b32 v68 offset:7072
    ds_write_addtid_b32 v72 offset:8160
    v_pk_mul_f32 v[30:31], v[46:47], v[16:17] op_sel:[0,0] op_sel_hi:[0,1]
    v_pk_mul_f32 v[32:33], v[46:47], v[18:19] op_sel:[0,0] op_sel_hi:[0,1]
    v_pk_fma_f32 v[50:51], v[46:47], v[16:17], v[30:31] op_sel:[1,1,0] op_sel_hi:[1,0,1] neg_lo:[1,0,0]
    v_pk_fma_f32 v[52:53], v[46:47], v[18:19], v[32:33] op_sel:[1,1,0] op_sel_hi:[1,0,1] neg_lo:[1,0,0]
    v_cvt_pk_bf16_f32 v69, v50, -v51
    v_cvt_pk_bf16_f32 v73, v52, -v53
    ds_write_addtid_b32 v69 offset:7344
    ds_write_addtid_b32 v73 offset:8432
    ds_read_b64 v[92:93], v3 offset:4352
    ds_read_b64 v[94:95], v2 offset:4352
    ds_read_b64 v[96:97], v3 offset:4368
    ds_read_b64 v[98:99], v2 offset:4368
    ds_read_b64 v[100:101], v3 offset:4384
    ds_read_b64 v[102:103], v2 offset:4384
    ds_read_b64 v[104:105], v3 offset:4400
    ds_read_b64 v[106:107], v2 offset:4400
    v_pk_mul_f32 v[30:31], v[20:21], v[14:15] op_sel:[0,0] op_sel_hi:[0,1]
    v_pk_mul_f32 v[32:33], v[20:21], v[16:17] op_sel:[0,0] op_sel_hi:[0,1]
    v_pk_fma_f32 v[50:51], v[20:21], v[14:15], v[30:31] op_sel:[1,1,0] op_sel_hi:[1,0,1] neg_lo:[1,0,0]
    v_pk_fma_f32 v[52:53], v[20:21], v[16:17], v[32:33] op_sel:[1,1,0] op_sel_hi:[1,0,1] neg_lo:[1,0,0]
    v_pk_mul_f32 v[30:31], v[20:21], v[18:19] op_sel:[0,0] op_sel_hi:[0,1]
    v_pk_mul_f32 v[32:33], v[20:21], v[20:21] op_sel:[0,0] op_sel_hi:[0,1]
    v_pk_fma_f32 v[54:55], v[20:21], v[18:19], v[30:31] op_sel:[1,1,0] op_sel_hi:[1,0,1] neg_lo:[1,0,0]
    v_pk_fma_f32 v[56:57], v[20:21], v[20:21], v[32:33] op_sel:[1,1,0] op_sel_hi:[1,0,1] neg_lo:[1,0,0]
    v_pk_mul_f32 v[30:31], v[20:21], v[42:43] op_sel:[0,0] op_sel_hi:[0,1]
    v_pk_mul_f32 v[32:33], v[50:51], v[42:43] op_sel:[0,0] op_sel_hi:[0,1]
    v_pk_fma_f32 v[58:59], v[20:21], v[42:43], v[30:31] op_sel:[1,1,0] op_sel_hi:[1,0,1] neg_lo:[1,0,0]
    v_pk_fma_f32 v[60:61], v[50:51], v[42:43], v[32:33] op_sel:[1,1,0] op_sel_hi:[1,0,1] neg_lo:[1,0,0]
    v_pk_mul_f32 v[30:31], v[52:53], v[42:43] op_sel:[0,0] op_sel_hi:[0,1]
    v_pk_mul_f32 v[32:33], v[54:55], v[42:43] op_sel:[0,0] op_sel_hi:[0,1]
    v_pk_fma_f32 v[62:63], v[52:53], v[42:43], v[30:31] op_sel:[1,1,0] op_sel_hi:[1,0,1] neg_lo:[1,0,0]
    v_pk_fma_f32 v[64:65], v[54:55], v[42:43], v[32:33] op_sel:[1,1,0] op_sel_hi:[1,0,1] neg_lo:[1,0,0]
    s_waitcnt lgkmcnt(0)
    v_mfma_f32_16x16x32_bf16 v[112:115], v[92:95], v[76:79], v[112:115]
    v_cvt_pk_bf16_f32 v66, v20, -v21
    ds_write_addtid_b32 v66 offset:4352
    v_cvt_pk_bf16_f32 v67, v58, -v59
    ds_write_addtid_b32 v67 offset:4624
    v_cvt_pk_bf16_f32 v68, v50, -v51
    v_mfma_f32_16x16x32_bf16 v[112:115], v[96:99], v[80:83], v[112:115]
    ds_write_addtid_b32 v68 offset:4896
    v_cvt_pk_bf16_f32 v69, v60, -v61
    ds_write_addtid_b32 v69 offset:5168
    v_cvt_pk_bf16_f32 v66, v52, -v53
    v_mfma_f32_16x16x32_bf16 v[112:115], v[100:103], v[84:87], v[112:115]
    ds_write_addtid_b32 v66 offset:5440
    v_cvt_pk_bf16_f32 v67, v62, -v63
    ds_write_addtid_b32 v67 offset:5712
    v_cvt_pk_bf16_f32 v68, v54, -v55
    ds_write_addtid_b32 v68 offset:5984
    v_mfma_f32_16x16x32_bf16 v[112:115], v[104:107], v[88:91], v[112:115]
    v_cvt_pk_bf16_f32 v69, v64, -v65
    ds_write_addtid_b32 v69 offset:6256
    v_cvt_pk_bf16_f32 v66, v56, -v57
    ds_write_addtid_b32 v66 offset:6528
    ds_read_b64 v[92:93], v3 offset:4352
    ds_read_b64 v[94:95], v2 offset:4352
    ds_read_b64 v[96:97], v3 offset:4368
    ds_read_b64 v[98:99], v2 offset:4368
    ds_read_b64 v[100:101], v3 offset:4384
    ds_read_b64 v[102:103], v2 offset:4384
    ds_read_b64 v[104:105], v3 offset:4400
    ds_read_b64 v[106:107], v2 offset:4400
    v_lshlrev_b32 v212, 16, v212
    v_lshlrev_b32 v213, 16, v213
    v_lshlrev_b32 v214, 16, v214
    v_lshlrev_b32 v215, 16, v215
    v_lshlrev_b32 v216, 16, v216
    v_lshlrev_b32 v217, 16, v217
    v_mul_f32 v6, v218, v212
    v_mul_f32 v7, v218, v213
    v_mul_f32 v6, 0x3fb8aa3b, v6
    v_mul_f32 v7, 0.15915494, v7
    v_mul_f32 v8, v218, v214
    v_mul_f32 v9, v218, v215
    v_pk_mul_f32 v[30:31], v[216:217], v[8:9] op_sel:[0,0] op_sel_hi:[0,1]
    v_pk_fma_f32 v[24:25], v[216:217], v[8:9], v[30:31] op_sel:[1,1,0] op_sel_hi:[1,0,1] neg_lo:[1,0,0]
    v_exp_f32 v32, v6
    v_fract_f32 v34, v7
    v_cos_f32 v10, v34
    v_sin_f32 v11, v34
    s_nop 0
    v_mul_f32 v10, v10, v32
    v_mul_f32 v11, v11, v32
    v_mul_f32 v32, 0x41800000, v6
    v_mul_f32 v34, 0x41800000, v7
    v_exp_f32 v32, v32
    v_fract_f32 v34, v34
    v_cos_f32 v12, v34
    v_sin_f32 v13, v34
    s_nop 0
    v_mul_f32 v12, v12, v32
    v_mul_f32 v13, v13, v32
    v_mul_f32 v32, 0x43800000, v6
    v_mul_f32 v34, 0x43800000, v7
    v_exp_f32 v32, v32
    v_fract_f32 v34, v34
    v_cos_f32 v14, v34
    v_sin_f32 v15, v34
    s_nop 0
    v_mul_f32 v14, v14, v32
    v_mul_f32 v15, v15, v32
    s_waitcnt lgkmcnt(0)
    v_mfma_f32_16x16x32_bf16 v[116:119], v[92:95], v[76:79], v[116:119]
    v_mfma_f32_16x16x32_bf16 v[116:119], v[96:99], v[80:83], v[116:119]
    v_mfma_f32_16x16x32_bf16 v[116:119], v[100:103], v[84:87], v[116:119]
    v_mfma_f32_16x16x32_bf16 v[116:119], v[104:107], v[88:91], v[116:119]
    v_mov_b32 v26, v24
    v_mov_b32 v28, 1.0
    v_mov_b32 v27, v25
    v_mov_b32 v29, 0
    v_cvt_pk_bf16_f32 v67, v26, v27
    v_cvt_pk_bf16_f32 v70, v28, -v29
    ds_write_addtid_b32 v67 offset:0
    ds_write_addtid_b32 v70 offset:4352
    v_pk_mul_f32 v[30:31], v[26:27], v[12:13] op_sel:[0,0] op_sel_hi:[0,1]
    v_mov_b32 v28, v10
    v_pk_fma_f32 v[26:27], v[26:27], v[12:13], v[30:31] op_sel:[1,1,0] op_sel_hi:[1,0,1] neg_lo:[1,0,0]
    v_mov_b32 v29, v11
    v_cvt_pk_bf16_f32 v68, v26, v27
    v_cvt_pk_bf16_f32 v71, v28, -v29
    ds_write_addtid_b32 v68 offset:272
    ds_write_addtid_b32 v71 offset:4624
    v_pk_mul_f32 v[30:31], v[26:27], v[12:13] op_sel:[0,0] op_sel_hi:[0,1]
    v_pk_mul_f32 v[32:33], v[28:29], v[10:11] op_sel:[0,0] op_sel_hi:[0,1]
    v_pk_fma_f32 v[26:27], v[26:27], v[12:13], v[30:31] op_sel:[1,1,0] op_sel_hi:[1,0,1] neg_lo:[1,0,0]
    v_pk_fma_f32 v[36:37], v[28:29], v[10:11], v[32:33] op_sel:[1,1,0] op_sel_hi:[1,0,1] neg_lo:[1,0,0]
    v_cvt_pk_bf16_f32 v69, v26, v27
    v_cvt_pk_bf16_f32 v72, v36, -v37
    ds_write_addtid_b32 v69 offset:544
    ds_write_addtid_b32 v72 offset:4896
    v_pk_mul_f32 v[30:31], v[26:27], v[12:13] op_sel:[0,0] op_sel_hi:[0,1]
    v_pk_mul_f32 v[32:33], v[36:37], v[10:11] op_sel:[0,0] op_sel_hi:[0,1]
    v_pk_fma_f32 v[26:27], v[26:27], v[12:13], v[30:31] op_sel:[1,1,0] op_sel_hi:[1,0,1] neg_lo:[1,0,0]
    v_pk_fma_f32 v[28:29], v[36:37], v[10:11], v[32:33] op_sel:[1,1,0] op_sel_hi:[1,0,1] neg_lo:[1,0,0]
    v_cvt_pk_bf16_f32 v66, v26, v27
    v_cvt_pk_bf16_f32 v73, v28, -v29
    ds_write_addtid_b32 v66 offset:816
    ds_write_addtid_b32 v73 offset:5168
    v_pk_mul_f32 v[30:31], v[26:27], v[12:13] op_sel:[0,0] op_sel_hi:[0,1]
    v_pk_mul_f32 v[32:33], v[28:29], v[10:11] op_sel:[0,0] op_sel_hi:[0,1]
    v_pk_fma_f32 v[26:27], v[26:27], v[12:13], v[30:31] op_sel:[1,1,0] op_sel_hi:[1,0,1] neg_lo:[1,0,0]
    v_pk_fma_f32 v[38:39], v[28:29], v[10:11], v[32:33] op_sel:[1,1,0] op_sel_hi:[1,0,1] neg_lo:[1,0,0]
    v_cvt_pk_bf16_f32 v67, v26, v27
    v_cvt_pk_bf16_f32 v70, v38, -v39
    ds_write_addtid_b32 v67 offset:1088
    ds_write_addtid_b32 v70 offset:5440
    v_pk_mul_f32 v[30:31], v[26:27], v[12:13] op_sel:[0,0] op_sel_hi:[0,1]
    v_pk_mul_f32 v[32:33], v[38:39], v[10:11] op_sel:[0,0] op_sel_hi:[0,1]
    v_pk_fma_f32 v[26:27], v[26:27], v[12:13], v[30:31] op_sel:[1,1,0] op_sel_hi:[1,0,1] neg_lo:[1,0,0]
    v_pk_fma_f32 v[28:29], v[38:39], v[10:11], v[32:33] op_sel:[1,1,0] op_sel_hi:[1,0,1] neg_lo:[1,0,0]
    v_cvt_pk_bf16_f32 v68, v26, v27
    v_cvt_pk_bf16_f32 v71, v28, -v29
    ds_write_addtid_b32 v68 offset:1360
    ds_write_addtid_b32 v71 offset:5712
    v_pk_mul_f32 v[30:31], v[26:27], v[12:13] op_sel:[0,0] op_sel_hi:[0,1]
    v_pk_mul_f32 v[32:33], v[28:29], v[10:11] op_sel:[0,0] op_sel_hi:[0,1]
    v_pk_fma_f32 v[26:27], v[26:27], v[12:13], v[30:31] op_sel:[1,1,0] op_sel_hi:[1,0,1] neg_lo:[1,0,0]
    v_pk_fma_f32 v[40:41], v[28:29], v[10:11], v[32:33] op_sel:[1,1,0] op_sel_hi:[1,0,1] neg_lo:[1,0,0]
    v_cvt_pk_bf16_f32 v69, v26, v27
    v_cvt_pk_bf16_f32 v72, v40, -v41
    ds_write_addtid_b32 v69 offset:1632
    ds_write_addtid_b32 v72 offset:5984
    v_pk_mul_f32 v[30:31], v[26:27], v[12:13] op_sel:[0,0] op_sel_hi:[0,1]
    v_pk_mul_f32 v[32:33], v[40:41], v[10:11] op_sel:[0,0] op_sel_hi:[0,1]
    v_pk_fma_f32 v[26:27], v[26:27], v[12:13], v[30:31] op_sel:[1,1,0] op_sel_hi:[1,0,1] neg_lo:[1,0,0]
    v_pk_fma_f32 v[28:29], v[40:41], v[10:11], v[32:33] op_sel:[1,1,0] op_sel_hi:[1,0,1] neg_lo:[1,0,0]
    v_cvt_pk_bf16_f32 v66, v26, v27
    v_cvt_pk_bf16_f32 v73, v28, -v29
    ds_write_addtid_b32 v66 offset:1904
    ds_write_addtid_b32 v73 offset:6256
    v_pk_mul_f32 v[30:31], v[26:27], v[12:13] op_sel:[0,0] op_sel_hi:[0,1]
    v_pk_mul_f32 v[32:33], v[28:29], v[10:11] op_sel:[0,0] op_sel_hi:[0,1]
    v_pk_fma_f32 v[26:27], v[26:27], v[12:13], v[30:31] op_sel:[1,1,0] op_sel_hi:[1,0,1] neg_lo:[1,0,0]
    v_pk_fma_f32 v[42:43], v[28:29], v[10:11], v[32:33] op_sel:[1,1,0] op_sel_hi:[1,0,1] neg_lo:[1,0,0]
    v_cvt_pk_bf16_f32 v67, v26, v27
    v_cvt_pk_bf16_f32 v70, v42, -v43
    ds_write_addtid_b32 v67 offset:2176
    ds_write_addtid_b32 v70 offset:6528
    v_pk_mul_f32 v[30:31], v[26:27], v[12:13] op_sel:[0,0] op_sel_hi:[0,1]
    v_pk_mul_f32 v[32:33], v[42:43], v[10:11] op_sel:[0,0] op_sel_hi:[0,1]
    v_pk_fma_f32 v[26:27], v[26:27], v[12:13], v[30:31] op_sel:[1,1,0] op_sel_hi:[1,0,1] neg_lo:[1,0,0]
    v_pk_fma_f32 v[28:29], v[42:43], v[10:11], v[32:33] op_sel:[1,1,0] op_sel_hi:[1,0,1] neg_lo:[1,0,0]
    v_cvt_pk_bf16_f32 v68, v26, v27
    v_cvt_pk_bf16_f32 v71, v28, -v29
    ds_write_addtid_b32 v68 offset:2448
    ds_write_addtid_b32 v71 offset:6800
    v_pk_mul_f32 v[30:31], v[26:27], v[12:13] op_sel:[0,0] op_sel_hi:[0,1]
    v_pk_mul_f32 v[32:33], v[28:29], v[10:11] op_sel:[0,0] op_sel_hi:[0,1]
    v_pk_fma_f32 v[26:27], v[26:27], v[12:13], v[30:31] op_sel:[1,1,0] op_sel_hi:[1,0,1] neg_lo:[1,0,0]
    v_pk_fma_f32 v[44:45], v[28:29], v[10:11], v[32:33] op_sel:[1,1,0] op_sel_hi:[1,0,1] neg_lo:[1,0,0]
    v_cvt_pk_bf16_f32 v69, v26, v27
    v_cvt_pk_bf16_f32 v72, v44, -v45
    ds_write_addtid_b32 v69 offset:2720
    ds_write_addtid_b32 v72 offset:7072
    v_pk_mul_f32 v[30:31], v[26:27], v[12:13] op_sel:[0,0] op_sel_hi:[0,1]
    v_pk_mul_f32 v[32:33], v[44:45], v[10:11] op_sel:[0,0] op_sel_hi:[0,1]
    v_pk_fma_f32 v[26:27], v[26:27], v[12:13], v[30:31] op_sel:[1,1,0] op_sel_hi:[1,0,1] neg_lo:[1,0,0]
    v_pk_fma_f32 v[28:29], v[44:45], v[10:11], v[32:33] op_sel:[1,1,0] op_sel_hi:[1,0,1] neg_lo:[1,0,0]
    v_cvt_pk_bf16_f32 v66, v26, v27
    v_cvt_pk_bf16_f32 v73, v28, -v29
    ds_write_addtid_b32 v66 offset:2992
    ds_write_addtid_b32 v73 offset:7344
    v_pk_mul_f32 v[30:31], v[26:27], v[12:13] op_sel:[0,0] op_sel_hi:[0,1]
    v_pk_mul_f32 v[32:33], v[28:29], v[10:11] op_sel:[0,0] op_sel_hi:[0,1]
    v_pk_fma_f32 v[26:27], v[26:27], v[12:13], v[30:31] op_sel:[1,1,0] op_sel_hi:[1,0,1] neg_lo:[1,0,0]
    v_pk_fma_f32 v[46:47], v[28:29], v[10:11], v[32:33] op_sel:[1,1,0] op_sel_hi:[1,0,1] neg_lo:[1,0,0]
    v_cvt_pk_bf16_f32 v67, v26, v27
    v_cvt_pk_bf16_f32 v70, v46, -v47
    ds_write_addtid_b32 v67 offset:3264
    ds_write_addtid_b32 v70 offset:7616
    v_pk_mul_f32 v[30:31], v[26:27], v[12:13] op_sel:[0,0] op_sel_hi:[0,1]
    v_pk_mul_f32 v[32:33], v[46:47], v[10:11] op_sel:[0,0] op_sel_hi:[0,1]
    v_pk_fma_f32 v[26:27], v[26:27], v[12:13], v[30:31] op_sel:[1,1,0] op_sel_hi:[1,0,1] neg_lo:[1,0,0]
    v_pk_fma_f32 v[28:29], v[46:47], v[10:11], v[32:33] op_sel:[1,1,0] op_sel_hi:[1,0,1] neg_lo:[1,0,0]
    v_cvt_pk_bf16_f32 v68, v26, v27
    v_cvt_pk_bf16_f32 v71, v28, -v29
    ds_write_addtid_b32 v68 offset:3536
    ds_write_addtid_b32 v71 offset:7888
    v_pk_mul_f32 v[30:31], v[26:27], v[12:13] op_sel:[0,0] op_sel_hi:[0,1]
    v_pk_mul_f32 v[32:33], v[28:29], v[10:11] op_sel:[0,0] op_sel_hi:[0,1]
    v_pk_fma_f32 v[26:27], v[26:27], v[12:13], v[30:31] op_sel:[1,1,0] op_sel_hi:[1,0,1] neg_lo:[1,0,0]
    v_pk_fma_f32 v[48:49], v[28:29], v[10:11], v[32:33] op_sel:[1,1,0] op_sel_hi:[1,0,1] neg_lo:[1,0,0]
    v_cvt_pk_bf16_f32 v69, v26, v27
    v_cvt_pk_bf16_f32 v72, v48, -v49
    ds_write_addtid_b32 v69 offset:3808
    ds_write_addtid_b32 v72 offset:8160
    v_pk_mul_f32 v[30:31], v[26:27], v[12:13] op_sel:[0,0] op_sel_hi:[0,1]
    v_pk_mul_f32 v[32:33], v[48:49], v[10:11] op_sel:[0,0] op_sel_hi:[0,1]
    v_pk_fma_f32 v[26:27], v[26:27], v[12:13], v[30:31] op_sel:[1,1,0] op_sel_hi:[1,0,1] neg_lo:[1,0,0]
    v_pk_fma_f32 v[28:29], v[48:49], v[10:11], v[32:33] op_sel:[1,1,0] op_sel_hi:[1,0,1] neg_lo:[1,0,0]
    v_cvt_pk_bf16_f32 v66, v26, v27
    v_cvt_pk_bf16_f32 v73, v28, -v29
    ds_write_addtid_b32 v66 offset:4080
    ds_write_addtid_b32 v73 offset:8432
    v_pk_mul_f32 v[30:31], v[14:15], v[14:15] op_sel:[0,0] op_sel_hi:[0,1]
    v_pk_fma_f32 v[16:17], v[14:15], v[14:15], v[30:31] op_sel:[1,1,0] op_sel_hi:[1,0,1] neg_lo:[1,0,0]
    ds_read_b64 v[76:77], v3 offset:0
    ds_read_b64 v[78:79], v2 offset:0
    ds_read_b64 v[80:81], v3 offset:16
    ds_read_b64 v[82:83], v2 offset:16
    ds_read_b64 v[84:85], v3 offset:32
    ds_read_b64 v[86:87], v2 offset:32
    ds_read_b64 v[88:89], v3 offset:48
    ds_read_b64 v[90:91], v2 offset:48
    ds_read_b64 v[92:93], v3 offset:4352
    ds_read_b64 v[94:95], v2 offset:4352
    ds_read_b64 v[96:97], v3 offset:4368
    ds_read_b64 v[98:99], v2 offset:4368
    ds_read_b64 v[100:101], v3 offset:4384
    ds_read_b64 v[102:103], v2 offset:4384
    ds_read_b64 v[104:105], v3 offset:4400
    ds_read_b64 v[106:107], v2 offset:4400
    v_pk_mul_f32 v[30:31], v[16:17], v[14:15] op_sel:[0,0] op_sel_hi:[0,1]
    v_pk_mul_f32 v[32:33], v[16:17], v[16:17] op_sel:[0,0] op_sel_hi:[0,1]
    v_pk_fma_f32 v[18:19], v[16:17], v[14:15], v[30:31] op_sel:[1,1,0] op_sel_hi:[1,0,1] neg_lo:[1,0,0]
    v_pk_fma_f32 v[20:21], v[16:17], v[16:17], v[32:33] op_sel:[1,1,0] op_sel_hi:[1,0,1] neg_lo:[1,0,0]
    v_pk_mul_f32 v[30:31], v[36:37], v[14:15] op_sel:[0,0] op_sel_hi:[0,1]
    v_pk_mul_f32 v[32:33], v[38:39], v[14:15] op_sel:[0,0] op_sel_hi:[0,1]
    v_pk_fma_f32 v[50:51], v[36:37], v[14:15], v[30:31] op_sel:[1,1,0] op_sel_hi:[1,0,1] neg_lo:[1,0,0]
    v_pk_fma_f32 v[52:53], v[38:39], v[14:15], v[32:33] op_sel:[1,1,0] op_sel_hi:[1,0,1] neg_lo:[1,0,0]
    v_pk_mul_f32 v[30:31], v[40:41], v[14:15] op_sel:[0,0] op_sel_hi:[0,1]
    v_pk_mul_f32 v[32:33], v[42:43], v[14:15] op_sel:[0,0] op_sel_hi:[0,1]
    v_pk_fma_f32 v[54:55], v[40:41], v[14:15], v[30:31] op_sel:[1,1,0] op_sel_hi:[1,0,1] neg_lo:[1,0,0]
    v_pk_fma_f32 v[56:57], v[42:43], v[14:15], v[32:33] op_sel:[1,1,0] op_sel_hi:[1,0,1] neg_lo:[1,0,0]
    v_pk_mul_f32 v[30:31], v[44:45], v[14:15] op_sel:[0,0] op_sel_hi:[0,1]
    v_pk_mul_f32 v[32:33], v[46:47], v[14:15] op_sel:[0,0] op_sel_hi:[0,1]
    v_pk_fma_f32 v[58:59], v[44:45], v[14:15], v[30:31] op_sel:[1,1,0] op_sel_hi:[1,0,1] neg_lo:[1,0,0]
    v_pk_fma_f32 v[60:61], v[46:47], v[14:15], v[32:33] op_sel:[1,1,0] op_sel_hi:[1,0,1] neg_lo:[1,0,0]
    v_pk_mul_f32 v[30:31], v[48:49], v[14:15] op_sel:[0,0] op_sel_hi:[0,1]
    v_pk_fma_f32 v[62:63], v[48:49], v[14:15], v[30:31] op_sel:[1,1,0] op_sel_hi:[1,0,1] neg_lo:[1,0,0]
    s_waitcnt lgkmcnt(0)
    v_mfma_f32_16x16x32_bf16 v[108:111], v[92:95], v[76:79], v[108:111]
    v_cvt_pk_bf16_f32 v67, v14, -v15
    ds_write_addtid_b32 v67 offset:4352
    v_cvt_pk_bf16_f32 v68, v50, -v51
    ds_write_addtid_b32 v68 offset:4624
    v_mfma_f32_16x16x32_bf16 v[108:111], v[96:99], v[80:83], v[108:111]
    v_cvt_pk_bf16_f32 v69, v52, -v53
    ds_write_addtid_b32 v69 offset:4896
    v_cvt_pk_bf16_f32 v66, v54, -v55
    ds_write_addtid_b32 v66 offset:5168
    v_mfma_f32_16x16x32_bf16 v[108:111], v[100:103], v[84:87], v[108:111]
    v_cvt_pk_bf16_f32 v67, v56, -v57
    ds_write_addtid_b32 v67 offset:5440
    v_cvt_pk_bf16_f32 v68, v58, -v59
    ds_write_addtid_b32 v68 offset:5712
    v_mfma_f32_16x16x32_bf16 v[108:111], v[104:107], v[88:91], v[108:111]
    v_cvt_pk_bf16_f32 v69, v60, -v61
    ds_write_addtid_b32 v69 offset:5984
    v_cvt_pk_bf16_f32 v66, v62, -v63
    ds_write_addtid_b32 v66 offset:6256
    v_cvt_pk_bf16_f32 v67, v16, -v17
    v_cvt_pk_bf16_f32 v70, v18, -v19
    ds_write_addtid_b32 v67 offset:6528
    ds_write_addtid_b32 v70 offset:7616
    v_pk_mul_f32 v[30:31], v[38:39], v[16:17] op_sel:[0,0] op_sel_hi:[0,1]
    v_pk_mul_f32 v[32:33], v[38:39], v[18:19] op_sel:[0,0] op_sel_hi:[0,1]
    v_pk_fma_f32 v[50:51], v[38:39], v[16:17], v[30:31] op_sel:[1,1,0] op_sel_hi:[1,0,1] neg_lo:[1,0,0]
    v_pk_fma_f32 v[52:53], v[38:39], v[18:19], v[32:33] op_sel:[1,1,0] op_sel_hi:[1,0,1] neg_lo:[1,0,0]
    v_cvt_pk_bf16_f32 v68, v50, -v51
    v_cvt_pk_bf16_f32 v71, v52, -v53
    ds_write_addtid_b32 v68 offset:6800
    ds_write_addtid_b32 v71 offset:7888
    v_pk_mul_f32 v[30:31], v[42:43], v[16:17] op_sel:[0,0] op_sel_hi:[0,1]
    v_pk_mul_f32 v[32:33], v[42:43], v[18:19] op_sel:[0,0] op_sel_hi:[0,1]
    v_pk_fma_f32 v[50:51], v[42:43], v[16:17], v[30:31] op_sel:[1,1,0] op_sel_hi:[1,0,1] neg_lo:[1,0,0]
    v_pk_fma_f32 v[52:53], v[42:43], v[18:19], v[32:33] op_sel:[1,1,0] op_sel_hi:[1,0,1] neg_lo:[1,0,0]
    v_cvt_pk_bf16_f32 v69, v50, -v51
    v_cvt_pk_bf16_f32 v72, v52, -v53
    ds_write_addtid_b32 v69 offset:7072
    ds_write_addtid_b32 v72 offset:8160
    v_pk_mul_f32 v[30:31], v[46:47], v[16:17] op_sel:[0,0] op_sel_hi:[0,1]
    v_pk_mul_f32 v[32:33], v[46:47], v[18:19] op_sel:[0,0] op_sel_hi:[0,1]
    v_pk_fma_f32 v[50:51], v[46:47], v[16:17], v[30:31] op_sel:[1,1,0] op_sel_hi:[1,0,1] neg_lo:[1,0,0]
    v_pk_fma_f32 v[52:53], v[46:47], v[18:19], v[32:33] op_sel:[1,1,0] op_sel_hi:[1,0,1] neg_lo:[1,0,0]
    v_cvt_pk_bf16_f32 v66, v50, -v51
    v_cvt_pk_bf16_f32 v73, v52, -v53
    ds_write_addtid_b32 v66 offset:7344
    ds_write_addtid_b32 v73 offset:8432
    ds_read_b64 v[92:93], v3 offset:4352
    ds_read_b64 v[94:95], v2 offset:4352
    ds_read_b64 v[96:97], v3 offset:4368
    ds_read_b64 v[98:99], v2 offset:4368
    ds_read_b64 v[100:101], v3 offset:4384
    ds_read_b64 v[102:103], v2 offset:4384
    ds_read_b64 v[104:105], v3 offset:4400
    ds_read_b64 v[106:107], v2 offset:4400
    v_pk_mul_f32 v[30:31], v[20:21], v[14:15] op_sel:[0,0] op_sel_hi:[0,1]
    v_pk_mul_f32 v[32:33], v[20:21], v[16:17] op_sel:[0,0] op_sel_hi:[0,1]
    v_pk_fma_f32 v[50:51], v[20:21], v[14:15], v[30:31] op_sel:[1,1,0] op_sel_hi:[1,0,1] neg_lo:[1,0,0]
    v_pk_fma_f32 v[52:53], v[20:21], v[16:17], v[32:33] op_sel:[1,1,0] op_sel_hi:[1,0,1] neg_lo:[1,0,0]
    v_pk_mul_f32 v[30:31], v[20:21], v[18:19] op_sel:[0,0] op_sel_hi:[0,1]
    v_pk_mul_f32 v[32:33], v[20:21], v[20:21] op_sel:[0,0] op_sel_hi:[0,1]
    v_pk_fma_f32 v[54:55], v[20:21], v[18:19], v[30:31] op_sel:[1,1,0] op_sel_hi:[1,0,1] neg_lo:[1,0,0]
    v_pk_fma_f32 v[56:57], v[20:21], v[20:21], v[32:33] op_sel:[1,1,0] op_sel_hi:[1,0,1] neg_lo:[1,0,0]
    v_pk_mul_f32 v[30:31], v[20:21], v[42:43] op_sel:[0,0] op_sel_hi:[0,1]
    v_pk_mul_f32 v[32:33], v[50:51], v[42:43] op_sel:[0,0] op_sel_hi:[0,1]
    v_pk_fma_f32 v[58:59], v[20:21], v[42:43], v[30:31] op_sel:[1,1,0] op_sel_hi:[1,0,1] neg_lo:[1,0,0]
    v_pk_fma_f32 v[60:61], v[50:51], v[42:43], v[32:33] op_sel:[1,1,0] op_sel_hi:[1,0,1] neg_lo:[1,0,0]
    v_pk_mul_f32 v[30:31], v[52:53], v[42:43] op_sel:[0,0] op_sel_hi:[0,1]
    v_pk_mul_f32 v[32:33], v[54:55], v[42:43] op_sel:[0,0] op_sel_hi:[0,1]
    v_pk_fma_f32 v[62:63], v[52:53], v[42:43], v[30:31] op_sel:[1,1,0] op_sel_hi:[1,0,1] neg_lo:[1,0,0]
    v_pk_fma_f32 v[64:65], v[54:55], v[42:43], v[32:33] op_sel:[1,1,0] op_sel_hi:[1,0,1] neg_lo:[1,0,0]
    s_waitcnt lgkmcnt(0)
    v_mfma_f32_16x16x32_bf16 v[112:115], v[92:95], v[76:79], v[112:115]
    v_cvt_pk_bf16_f32 v67, v20, -v21
    ds_write_addtid_b32 v67 offset:4352
    v_cvt_pk_bf16_f32 v68, v58, -v59
    ds_write_addtid_b32 v68 offset:4624
    v_cvt_pk_bf16_f32 v69, v50, -v51
    v_mfma_f32_16x16x32_bf16 v[112:115], v[96:99], v[80:83], v[112:115]
    ds_write_addtid_b32 v69 offset:4896
    v_cvt_pk_bf16_f32 v66, v60, -v61
    ds_write_addtid_b32 v66 offset:5168
    v_cvt_pk_bf16_f32 v67, v52, -v53
    v_mfma_f32_16x16x32_bf16 v[112:115], v[100:103], v[84:87], v[112:115]
    ds_write_addtid_b32 v67 offset:5440
    v_cvt_pk_bf16_f32 v68, v62, -v63
    ds_write_addtid_b32 v68 offset:5712
    v_cvt_pk_bf16_f32 v69, v54, -v55
    ds_write_addtid_b32 v69 offset:5984
    v_mfma_f32_16x16x32_bf16 v[112:115], v[104:107], v[88:91], v[112:115]
    v_cvt_pk_bf16_f32 v66, v64, -v65
    ds_write_addtid_b32 v66 offset:6256
    v_cvt_pk_bf16_f32 v67, v56, -v57
    ds_write_addtid_b32 v67 offset:6528
    ds_read_b64 v[92:93], v3 offset:4352
    ds_read_b64 v[94:95], v2 offset:4352
    ds_read_b64 v[96:97], v3 offset:4368
    ds_read_b64 v[98:99], v2 offset:4368
    ds_read_b64 v[100:101], v3 offset:4384
    ds_read_b64 v[102:103], v2 offset:4384
    ds_read_b64 v[104:105], v3 offset:4400
    ds_read_b64 v[106:107], v2 offset:4400
    s_waitcnt lgkmcnt(0)
    v_mfma_f32_16x16x32_bf16 v[116:119], v[92:95], v[76:79], v[116:119]
    v_mfma_f32_16x16x32_bf16 v[116:119], v[96:99], v[80:83], v[116:119]
    v_mfma_f32_16x16x32_bf16 v[116:119], v[100:103], v[84:87], v[116:119]
    v_mfma_f32_16x16x32_bf16 v[116:119], v[104:107], v[88:91], v[116:119]
    v_cmp_eq_u32 vcc, 0, v0
    v_and_b32 v4, 15, v0
    v_lshrrev_b32 v5, 4, v0
    v_cndmask_b32 v6, 0, v219, vcc
    v_lshlrev_b32 v7, 5, v4
    v_lshl_add_u32 v7, v5, 4, v7
    v_lshlrev_b32 v8, 4, v4
    v_lshl_add_u32 v8, v5, 8, v8
    v_cmp_gt_u32 vcc, 2, v5
    v_add_f32 v108, v108, v6
    s_nop 0
    v_cndmask_b32 v7, v8, v7, vcc
    v_add_u32 v7, s51, v7
    v_lshlrev_b32 v8, 3, v4
    v_lshl_add_u32 v8, v5, 8, v8
    v_add_u32 v8, s51, v8
    s_nop 4
    ds_write_b128 v7, v[112:115]
    ds_write_b64 v8, v[116:117] offset:1024
    ds_write_b64 v8, v[118:119] offset:1152
    v_cvt_pk_bf16_f32 v10, v111, v110
    v_cvt_pk_bf16_f32 v11, v109, v108
    v_lshlrev_b32 v9, 5, v4
    v_lshl_add_u32 v9, v5, 3, v9
    v_sub_u32 v9, 4088, v9
    v_add_u32 v9, s52, v9
    ds_write_b64 v9, v[10:11]
    v_and_b32 v9, 31, v0
    v_lshlrev_b32 v9, 2, v9
    v_add_u32 v9, s52, v9
    v_mov_b32 v12, 0
    ds_write_b32 v9, v12 offset:4096
    v_lshlrev_b32 v13, 4, v0
    v_add_u32 v14, s51, v13
    v_lshlrev_b32 v15, 3, v0
    v_add_u32 v15, s51, v15
    v_lshlrev_b32 v16, 2, v0
    v_add_u32 v16, s51, v16
    v_sub_u32 v13, s52, v13
    s_waitcnt lgkmcnt(0)
    ds_read_b128 v[20:23], v14
    ds_read_b32 v24, v14 offset:16
    ds_read_b64 v[26:27], v15 offset:512
    ds_read_b32 v28, v15 offset:520
    v_add_u32 v17, 1024, v16
    ds_read2_b32 v[30:31], v17 offset0:0 offset1:1
    ds_read2_b32 v[32:33], v17 offset0:64 offset1:65
    v_and_b32 v18, 1, v0
    v_cmp_eq_u32 vcc, 1, v18
    s_waitcnt lgkmcnt(0)
    v_cvt_pk_bf16_f32 v36, v28, v28
    v_cvt_pk_bf16_f32 v37, v27, v27
    v_cvt_pk_bf16_f32 v38, v27, v26
    v_cvt_pk_bf16_f32 v39, v26, v26
    ds_write_b128 v13, v[36:39] offset:3056
    v_cndmask_b32 v19, v30, v31, vcc
    v_cvt_pk_bf16_f32 v40, v31, v31
    v_cvt_pk_bf16_f32 v41, v31, v19
    v_cvt_pk_bf16_f32 v42, v30, v30
    v_mov_b32 v43, v42
    v_cndmask_b32 v19, v32, v33, vcc
    v_cvt_pk_bf16_f32 v44, v33, v33
    v_cvt_pk_bf16_f32 v45, v33, v19
    v_cvt_pk_bf16_f32 v46, v32, v32
    v_mov_b32 v47, v46
    ds_write_b128 v13, v[40:43] offset:2032
    ds_write_b128 v13, v[44:47] offset:1008
    v_cvt_pk_bf16_f32 v48, v24, v23
    v_cvt_pk_bf16_f32 v49, v22, v22
    v_cvt_pk_bf16_f32 v50, v22, v21
    v_cvt_pk_bf16_f32 v51, v20, v20
    s_mov_b32 exec_hi, 0
    ds_write_b128 v13, v[48:51] offset:3568
    s_mov_b32 exec_hi, -1
    s_mul_i32 s53, s66, 18560
    v_and_b32 v4, 3, v0
    v_mul_u32_u24 v4, 4640, v4
    v_bfe_u32 v5, v0, 2, 2
    v_lshl_add_u32 v4, v5, 7, v4
    v_lshrrev_b32 v5, 4, v0
    v_lshl_add_u32 v4, v5, 4, v4
    v_add_u32 v8, s53, v4
    v_and_b32 v6, 15, v0
    v_lshlrev_b32 v7, 3, v6
    v_sub_u32 v7, 120, v7
    v_lshl_add_u32 v7, v5, 4, v7
    v_add_u32 v9, s52, v7
    v_lshlrev_b32 v10, 3, v6
    v_lshl_add_u32 v10, v5, 7, v10
    s_waitcnt lgkmcnt(0)
    v_mov_b32 v12, 161692
    s_mov_b32 s69, 0
L_gated__ls_38:
    ds_read_b32 v13, v12
    s_waitcnt lgkmcnt(0)
    v_readfirstlane_b32 s78, v13
    s_nop 1
    s_cmp_eq_u32 s78, 1
    s_cbranch_scc1 L_gated__ld_39
    s_add_u32 s69, s69, 1
    s_cmp_lt_u32 s69, 0x400000
    s_cbranch_scc0 L_gated__ld_39
    s_sleep 1
    s_branch L_gated__ls_38
L_gated__ld_39:
    ds_read_b128 v[48:51], v8 offset:448
    ds_read_b64 v[80:81], v9 offset:4032
    ds_read_b64 v[82:83], v9 offset:4040
    ds_read_b128 v[52:55], v8 offset:960
    ds_read_b64 v[84:85], v9 offset:3520
    ds_read_b64 v[86:87], v9 offset:3528
    ds_read_b128 v[56:59], v8 offset:1472
    ds_read_b64 v[88:89], v9 offset:3008
    ds_read_b64 v[90:91], v9 offset:3016
    ds_read_b128 v[60:63], v8 offset:1984
    ds_read_b64 v[92:93], v9 offset:2496
    ds_read_b64 v[94:95], v9 offset:2504
    ds_read_b128 v[64:67], v8 offset:2496
    ds_read_b64 v[96:97], v9 offset:1984
    ds_read_b64 v[98:99], v9 offset:1992
    ds_read_b128 v[68:71], v8 offset:3008
    ds_read_b64 v[100:101], v9 offset:1472
    ds_read_b64 v[102:103], v9 offset:1480
    ds_read_b128 v[72:75], v8 offset:3520
    ds_read_b64 v[104:105], v9 offset:960
    ds_read_b64 v[106:107], v9 offset:968
    ds_read_b128 v[76:79], v8 offset:4032
    ds_read_b64 v[108:109], v9 offset:448
    ds_read_b64 v[110:111], v9 offset:456
    s_waitcnt lgkmcnt(0)
    v_mfma_f32_16x16x32_bf16 v[16:19], v[48:51], v[80:83], 0
    ds_read_b128 v[112:115], v8 offset:384
    v_mfma_f32_16x16x32_bf16 v[20:23], v[52:55], v[80:83], 0
    ds_read_b64 v[144:145], v9 offset:3968
    v_mfma_f32_16x16x32_bf16 v[24:27], v[56:59], v[80:83], 0
    ds_read_b64 v[146:147], v9 offset:3976
    v_mfma_f32_16x16x32_bf16 v[28:31], v[60:63], v[80:83], 0
    ds_read_b128 v[116:119], v8 offset:896
    v_mfma_f32_16x16x32_bf16 v[32:35], v[64:67], v[80:83], 0
    ds_read_b64 v[148:149], v9 offset:3456
    v_mfma_f32_16x16x32_bf16 v[36:39], v[68:71], v[80:83], 0
    ds_read_b64 v[150:151], v9 offset:3464
    v_mfma_f32_16x16x32_bf16 v[40:43], v[72:75], v[80:83], 0
    v_mfma_f32_16x16x32_bf16 v[44:47], v[76:79], v[80:83], 0
    ds_read_b128 v[120:123], v8 offset:1408
    v_mfma_f32_16x16x32_bf16 v[20:23], v[48:51], v[84:87], v[20:23]
    ds_read_b64 v[152:153], v9 offset:2944
    v_mfma_f32_16x16x32_bf16 v[24:27], v[52:55], v[84:87], v[24:27]
    ds_read_b64 v[154:155], v9 offset:2952
    v_mfma_f32_16x16x32_bf16 v[28:31], v[56:59], v[84:87], v[28:31]
    ds_read_b128 v[124:127], v8 offset:1920
    v_mfma_f32_16x16x32_bf16 v[32:35], v[60:63], v[84:87], v[32:35]
    ds_read_b64 v[156:157], v9 offset:2432
    v_mfma_f32_16x16x32_bf16 v[36:39], v[64:67], v[84:87], v[36:39]
    ds_read_b64 v[158:159], v9 offset:2440
    v_mfma_f32_16x16x32_bf16 v[40:43], v[68:71], v[84:87], v[40:43]
    v_mfma_f32_16x16x32_bf16 v[44:47], v[72:75], v[84:87], v[44:47]
    ds_read_b128 v[128:131], v8 offset:2432
    v_mfma_f32_16x16x32_bf16 v[24:27], v[48:51], v[88:91], v[24:27]
    ds_read_b64 v[160:161], v9 offset:1920
    v_mfma_f32_16x16x32_bf16 v[28:31], v[52:55], v[88:91], v[28:31]
    ds_read_b64 v[162:163], v9 offset:1928
    v_mfma_f32_16x16x32_bf16 v[32:35], v[56:59], v[88:91], v[32:35]
    ds_read_b128 v[132:135], v8 offset:2944
    v_mfma_f32_16x16x32_bf16 v[36:39], v[60:63], v[88:91], v[36:39]
    ds_read_b64 v[164:165], v9 offset:1408
    v_mfma_f32_16x16x32_bf16 v[40:43], v[64:67], v[88:91], v[40:43]
    ds_read_b64 v[166:167], v9 offset:1416
    v_mfma_f32_16x16x32_bf16 v[44:47], v[68:71], v[88:91], v[44:47]
    v_mfma_f32_16x16x32_bf16 v[28:31], v[48:51], v[92:95], v[28:31]
    ds_read_b128 v[136:139], v8 offset:3456
    v_mfma_f32_16x16x32_bf16 v[32:35], v[52:55], v[92:95], v[32:35]
    ds_read_b64 v[168:169], v9 offset:896
    v_mfma_f32_16x16x32_bf16 v[36:39], v[56:59], v[92:95], v[36:39]
    ds_read_b64 v[170:171], v9 offset:904
    v_mfma_f32_16x16x32_bf16 v[40:43], v[60:63], v[92:95], v[40:43]
    ds_read_b128 v[140:143], v8 offset:3968
    v_mfma_f32_16x16x32_bf16 v[44:47], v[64:67], v[92:95], v[44:47]
    ds_read_b64 v[172:173], v9 offset:384
    v_mfma_f32_16x16x32_bf16 v[32:35], v[48:51], v[96:99], v[32:35]
    ds_read_b64 v[174:175], v9 offset:392
    v_mfma_f32_16x16x32_bf16 v[36:39], v[52:55], v[96:99], v[36:39]
    v_mfma_f32_16x16x32_bf16 v[40:43], v[56:59], v[96:99], v[40:43]
    v_mfma_f32_16x16x32_bf16 v[44:47], v[60:63], v[96:99], v[44:47]
    v_mfma_f32_16x16x32_bf16 v[36:39], v[48:51], v[100:103], v[36:39]
    v_mfma_f32_16x16x32_bf16 v[40:43], v[52:55], v[100:103], v[40:43]
    v_mfma_f32_16x16x32_bf16 v[44:47], v[56:59], v[100:103], v[44:47]
    v_mfma_f32_16x16x32_bf16 v[40:43], v[48:51], v[104:107], v[40:43]
    v_mfma_f32_16x16x32_bf16 v[44:47], v[52:55], v[104:107], v[44:47]
    v_mfma_f32_16x16x32_bf16 v[44:47], v[48:51], v[108:111], v[44:47]
    s_waitcnt lgkmcnt(0)
    v_mfma_f32_16x16x32_bf16 v[16:19], v[112:115], v[144:147], v[16:19]
    ds_read_b128 v[48:51], v8 offset:320
    v_mfma_f32_16x16x32_bf16 v[20:23], v[116:119], v[144:147], v[20:23]
    ds_read_b64 v[80:81], v9 offset:3904
    v_mfma_f32_16x16x32_bf16 v[24:27], v[120:123], v[144:147], v[24:27]
    ds_read_b64 v[82:83], v9 offset:3912
    v_mfma_f32_16x16x32_bf16 v[28:31], v[124:127], v[144:147], v[28:31]
    ds_read_b128 v[52:55], v8 offset:832
    v_mfma_f32_16x16x32_bf16 v[32:35], v[128:131], v[144:147], v[32:35]
    ds_read_b64 v[84:85], v9 offset:3392
    v_mfma_f32_16x16x32_bf16 v[36:39], v[132:135], v[144:147], v[36:39]
    ds_read_b64 v[86:87], v9 offset:3400
    v_mfma_f32_16x16x32_bf16 v[40:43], v[136:139], v[144:147], v[40:43]
    v_mfma_f32_16x16x32_bf16 v[44:47], v[140:143], v[144:147], v[44:47]
    ds_read_b128 v[56:59], v8 offset:1344
    v_mfma_f32_16x16x32_bf16 v[20:23], v[112:115], v[148:151], v[20:23]
    ds_read_b64 v[88:89], v9 offset:2880
    v_mfma_f32_16x16x32_bf16 v[24:27], v[116:119], v[148:151], v[24:27]
    ds_read_b64 v[90:91], v9 offset:2888
    v_mfma_f32_16x16x32_bf16 v[28:31], v[120:123], v[148:151], v[28:31]
    ds_read_b128 v[60:63], v8 offset:1856
    v_mfma_f32_16x16x32_bf16 v[32:35], v[124:127], v[148:151], v[32:35]
    ds_read_b64 v[92:93], v9 offset:2368
    v_mfma_f32_16x16x32_bf16 v[36:39], v[128:131], v[148:151], v[36:39]
    ds_read_b64 v[94:95], v9 offset:2376
    v_mfma_f32_16x16x32_bf16 v[40:43], v[132:135], v[148:151], v[40:43]
    v_mfma_f32_16x16x32_bf16 v[44:47], v[136:139], v[148:151], v[44:47]
    ds_read_b128 v[64:67], v8 offset:2368
    v_mfma_f32_16x16x32_bf16 v[24:27], v[112:115], v[152:155], v[24:27]
    ds_read_b64 v[96:97], v9 offset:1856
    v_mfma_f32_16x16x32_bf16 v[28:31], v[116:119], v[152:155], v[28:31]
    ds_read_b64 v[98:99], v9 offset:1864
    v_mfma_f32_16x16x32_bf16 v[32:35], v[120:123], v[152:155], v[32:35]
    ds_read_b128 v[68:71], v8 offset:2880
    v_mfma_f32_16x16x32_bf16 v[36:39], v[124:127], v[152:155], v[36:39]
    ds_read_b64 v[100:101], v9 offset:1344
    v_mfma_f32_16x16x32_bf16 v[40:43], v[128:131], v[152:155], v[40:43]
    ds_read_b64 v[102:103], v9 offset:1352
    v_mfma_f32_16x16x32_bf16 v[44:47], v[132:135], v[152:155], v[44:47]
    v_mfma_f32_16x16x32_bf16 v[28:31], v[112:115], v[156:159], v[28:31]
    ds_read_b128 v[72:75], v8 offset:3392
    v_mfma_f32_16x16x32_bf16 v[32:35], v[116:119], v[156:159], v[32:35]
    ds_read_b64 v[104:105], v9 offset:832
    v_mfma_f32_16x16x32_bf16 v[36:39], v[120:123], v[156:159], v[36:39]
    ds_read_b64 v[106:107], v9 offset:840
    v_mfma_f32_16x16x32_bf16 v[40:43], v[124:127], v[156:159], v[40:43]
    ds_read_b128 v[76:79], v8 offset:3904
    v_mfma_f32_16x16x32_bf16 v[44:47], v[128:131], v[156:159], v[44:47]
    ds_read_b64 v[108:109], v9 offset:320
    v_mfma_f32_16x16x32_bf16 v[32:35], v[112:115], v[160:163], v[32:35]
    ds_read_b64 v[110:111], v9 offset:328
    v_mfma_f32_16x16x32_bf16 v[36:39], v[116:119], v[160:163], v[36:39]
    v_mfma_f32_16x16x32_bf16 v[40:43], v[120:123], v[160:163], v[40:43]
    v_mfma_f32_16x16x32_bf16 v[44:47], v[124:127], v[160:163], v[44:47]
    v_mfma_f32_16x16x32_bf16 v[36:39], v[112:115], v[164:167], v[36:39]
    v_mfma_f32_16x16x32_bf16 v[40:43], v[116:119], v[164:167], v[40:43]
    v_mfma_f32_16x16x32_bf16 v[44:47], v[120:123], v[164:167], v[44:47]
    v_mfma_f32_16x16x32_bf16 v[40:43], v[112:115], v[168:171], v[40:43]
    v_mfma_f32_16x16x32_bf16 v[44:47], v[116:119], v[168:171], v[44:47]
    v_mfma_f32_16x16x32_bf16 v[44:47], v[112:115], v[172:175], v[44:47]
    s_waitcnt lgkmcnt(0)
    v_mfma_f32_16x16x32_bf16 v[16:19], v[48:51], v[80:83], v[16:19]
    ds_read_b128 v[112:115], v8 offset:256
    v_mfma_f32_16x16x32_bf16 v[20:23], v[52:55], v[80:83], v[20:23]
    ds_read_b64 v[144:145], v9 offset:3840
    v_mfma_f32_16x16x32_bf16 v[24:27], v[56:59], v[80:83], v[24:27]
    ds_read_b64 v[146:147], v9 offset:3848
    v_mfma_f32_16x16x32_bf16 v[28:31], v[60:63], v[80:83], v[28:31]
    ds_read_b128 v[116:119], v8 offset:768
    v_mfma_f32_16x16x32_bf16 v[32:35], v[64:67], v[80:83], v[32:35]
    ds_read_b64 v[148:149], v9 offset:3328
    v_mfma_f32_16x16x32_bf16 v[36:39], v[68:71], v[80:83], v[36:39]
    ds_read_b64 v[150:151], v9 offset:3336
    v_mfma_f32_16x16x32_bf16 v[40:43], v[72:75], v[80:83], v[40:43]
    v_mfma_f32_16x16x32_bf16 v[44:47], v[76:79], v[80:83], v[44:47]
    ds_read_b128 v[120:123], v8 offset:1280
    v_mfma_f32_16x16x32_bf16 v[20:23], v[48:51], v[84:87], v[20:23]
    ds_read_b64 v[152:153], v9 offset:2816
    v_mfma_f32_16x16x32_bf16 v[24:27], v[52:55], v[84:87], v[24:27]
    ds_read_b64 v[154:155], v9 offset:2824
    v_mfma_f32_16x16x32_bf16 v[28:31], v[56:59], v[84:87], v[28:31]
    ds_read_b128 v[124:127], v8 offset:1792
    v_mfma_f32_16x16x32_bf16 v[32:35], v[60:63], v[84:87], v[32:35]
    ds_read_b64 v[156:157], v9 offset:2304
    v_mfma_f32_16x16x32_bf16 v[36:39], v[64:67], v[84:87], v[36:39]
    ds_read_b64 v[158:159], v9 offset:2312
    v_mfma_f32_16x16x32_bf16 v[40:43], v[68:71], v[84:87], v[40:43]
    v_mfma_f32_16x16x32_bf16 v[44:47], v[72:75], v[84:87], v[44:47]
    ds_read_b128 v[128:131], v8 offset:2304
    v_mfma_f32_16x16x32_bf16 v[24:27], v[48:51], v[88:91], v[24:27]
    ds_read_b64 v[160:161], v9 offset:1792
    v_mfma_f32_16x16x32_bf16 v[28:31], v[52:55], v[88:91], v[28:31]
    ds_read_b64 v[162:163], v9 offset:1800
    v_mfma_f32_16x16x32_bf16 v[32:35], v[56:59], v[88:91], v[32:35]
    ds_read_b128 v[132:135], v8 offset:2816
    v_mfma_f32_16x16x32_bf16 v[36:39], v[60:63], v[88:91], v[36:39]
    ds_read_b64 v[164:165], v9 offset:1280
    v_mfma_f32_16x16x32_bf16 v[40:43], v[64:67], v[88:91], v[40:43]
    ds_read_b64 v[166:167], v9 offset:1288
    v_mfma_f32_16x16x32_bf16 v[44:47], v[68:71], v[88:91], v[44:47]
    v_mfma_f32_16x16x32_bf16 v[28:31], v[48:51], v[92:95], v[28:31]
    ds_read_b128 v[136:139], v8 offset:3328
    v_mfma_f32_16x16x32_bf16 v[32:35], v[52:55], v[92:95], v[32:35]
    ds_read_b64 v[168:169], v9 offset:768
    v_mfma_f32_16x16x32_bf16 v[36:39], v[56:59], v[92:95], v[36:39]
    ds_read_b64 v[170:171], v9 offset:776
    v_mfma_f32_16x16x32_bf16 v[40:43], v[60:63], v[92:95], v[40:43]
    ds_read_b128 v[140:143], v8 offset:3840
    v_mfma_f32_16x16x32_bf16 v[44:47], v[64:67], v[92:95], v[44:47]
    ds_read_b64 v[172:173], v9 offset:256
    v_mfma_f32_16x16x32_bf16 v[32:35], v[48:51], v[96:99], v[32:35]
    ds_read_b64 v[174:175], v9 offset:264
    v_mfma_f32_16x16x32_bf16 v[36:39], v[52:55], v[96:99], v[36:39]
    v_mfma_f32_16x16x32_bf16 v[40:43], v[56:59], v[96:99], v[40:43]
    v_mfma_f32_16x16x32_bf16 v[44:47], v[60:63], v[96:99], v[44:47]
    v_mfma_f32_16x16x32_bf16 v[36:39], v[48:51], v[100:103], v[36:39]
    v_mfma_f32_16x16x32_bf16 v[40:43], v[52:55], v[100:103], v[40:43]
    v_mfma_f32_16x16x32_bf16 v[44:47], v[56:59], v[100:103], v[44:47]
    v_mfma_f32_16x16x32_bf16 v[40:43], v[48:51], v[104:107], v[40:43]
    v_mfma_f32_16x16x32_bf16 v[44:47], v[52:55], v[104:107], v[44:47]
    v_mfma_f32_16x16x32_bf16 v[44:47], v[48:51], v[108:111], v[44:47]
    s_waitcnt lgkmcnt(0)
    v_mfma_f32_16x16x32_bf16 v[16:19], v[112:115], v[144:147], v[16:19]
    ds_read_b128 v[48:51], v8 offset:192
    v_mfma_f32_16x16x32_bf16 v[20:23], v[116:119], v[144:147], v[20:23]
    ds_read_b64 v[80:81], v9 offset:3776
    v_mfma_f32_16x16x32_bf16 v[24:27], v[120:123], v[144:147], v[24:27]
    ds_read_b64 v[82:83], v9 offset:3784
    v_mfma_f32_16x16x32_bf16 v[28:31], v[124:127], v[144:147], v[28:31]
    ds_read_b128 v[52:55], v8 offset:704
    v_mfma_f32_16x16x32_bf16 v[32:35], v[128:131], v[144:147], v[32:35]
    ds_read_b64 v[84:85], v9 offset:3264
    v_mfma_f32_16x16x32_bf16 v[36:39], v[132:135], v[144:147], v[36:39]
    ds_read_b64 v[86:87], v9 offset:3272
    v_mfma_f32_16x16x32_bf16 v[40:43], v[136:139], v[144:147], v[40:43]
    v_mfma_f32_16x16x32_bf16 v[44:47], v[140:143], v[144:147], v[44:47]
    ds_read_b128 v[56:59], v8 offset:1216
    v_mfma_f32_16x16x32_bf16 v[20:23], v[112:115], v[148:151], v[20:23]
    ds_read_b64 v[88:89], v9 offset:2752
    v_mfma_f32_16x16x32_bf16 v[24:27], v[116:119], v[148:151], v[24:27]
    ds_read_b64 v[90:91], v9 offset:2760
    v_mfma_f32_16x16x32_bf16 v[28:31], v[120:123], v[148:151], v[28:31]
    ds_read_b128 v[60:63], v8 offset:1728
    v_mfma_f32_16x16x32_bf16 v[32:35], v[124:127], v[148:151], v[32:35]
    ds_read_b64 v[92:93], v9 offset:2240
    v_mfma_f32_16x16x32_bf16 v[36:39], v[128:131], v[148:151], v[36:39]
    ds_read_b64 v[94:95], v9 offset:2248
    v_mfma_f32_16x16x32_bf16 v[40:43], v[132:135], v[148:151], v[40:43]
    v_mfma_f32_16x16x32_bf16 v[44:47], v[136:139], v[148:151], v[44:47]
    ds_read_b128 v[64:67], v8 offset:2240
    v_mfma_f32_16x16x32_bf16 v[24:27], v[112:115], v[152:155], v[24:27]
    ds_read_b64 v[96:97], v9 offset:1728
    v_mfma_f32_16x16x32_bf16 v[28:31], v[116:119], v[152:155], v[28:31]
    ds_read_b64 v[98:99], v9 offset:1736
    v_mfma_f32_16x16x32_bf16 v[32:35], v[120:123], v[152:155], v[32:35]
    ds_read_b128 v[68:71], v8 offset:2752
    v_mfma_f32_16x16x32_bf16 v[36:39], v[124:127], v[152:155], v[36:39]
    ds_read_b64 v[100:101], v9 offset:1216
    v_mfma_f32_16x16x32_bf16 v[40:43], v[128:131], v[152:155], v[40:43]
    ds_read_b64 v[102:103], v9 offset:1224
    v_mfma_f32_16x16x32_bf16 v[44:47], v[132:135], v[152:155], v[44:47]
    v_mfma_f32_16x16x32_bf16 v[28:31], v[112:115], v[156:159], v[28:31]
    ds_read_b128 v[72:75], v8 offset:3264
    v_mfma_f32_16x16x32_bf16 v[32:35], v[116:119], v[156:159], v[32:35]
    ds_read_b64 v[104:105], v9 offset:704
    v_mfma_f32_16x16x32_bf16 v[36:39], v[120:123], v[156:159], v[36:39]
    ds_read_b64 v[106:107], v9 offset:712
    v_mfma_f32_16x16x32_bf16 v[40:43], v[124:127], v[156:159], v[40:43]
    ds_read_b128 v[76:79], v8 offset:3776
    v_mfma_f32_16x16x32_bf16 v[44:47], v[128:131], v[156:159], v[44:47]
    ds_read_b64 v[108:109], v9 offset:192
    v_mfma_f32_16x16x32_bf16 v[32:35], v[112:115], v[160:163], v[32:35]
    ds_read_b64 v[110:111], v9 offset:200
    v_mfma_f32_16x16x32_bf16 v[36:39], v[116:119], v[160:163], v[36:39]
    v_mfma_f32_16x16x32_bf16 v[40:43], v[120:123], v[160:163], v[40:43]
    v_mfma_f32_16x16x32_bf16 v[44:47], v[124:127], v[160:163], v[44:47]
    v_mfma_f32_16x16x32_bf16 v[36:39], v[112:115], v[164:167], v[36:39]
    v_mfma_f32_16x16x32_bf16 v[40:43], v[116:119], v[164:167], v[40:43]
    v_mfma_f32_16x16x32_bf16 v[44:47], v[120:123], v[164:167], v[44:47]
    v_mfma_f32_16x16x32_bf16 v[40:43], v[112:115], v[168:171], v[40:43]
    v_mfma_f32_16x16x32_bf16 v[44:47], v[116:119], v[168:171], v[44:47]
    v_mfma_f32_16x16x32_bf16 v[44:47], v[112:115], v[172:175], v[44:47]
    s_waitcnt lgkmcnt(0)
    v_mfma_f32_16x16x32_bf16 v[16:19], v[48:51], v[80:83], v[16:19]
    ds_read_b128 v[112:115], v8 offset:128
    v_mfma_f32_16x16x32_bf16 v[20:23], v[52:55], v[80:83], v[20:23]
    ds_read_b64 v[144:145], v9 offset:3712
    v_mfma_f32_16x16x32_bf16 v[24:27], v[56:59], v[80:83], v[24:27]
    ds_read_b64 v[146:147], v9 offset:3720
    v_mfma_f32_16x16x32_bf16 v[28:31], v[60:63], v[80:83], v[28:31]
    ds_read_b128 v[116:119], v8 offset:640
    v_mfma_f32_16x16x32_bf16 v[32:35], v[64:67], v[80:83], v[32:35]
    ds_read_b64 v[148:149], v9 offset:3200
    v_mfma_f32_16x16x32_bf16 v[36:39], v[68:71], v[80:83], v[36:39]
    ds_read_b64 v[150:151], v9 offset:3208
    v_mfma_f32_16x16x32_bf16 v[40:43], v[72:75], v[80:83], v[40:43]
    v_mfma_f32_16x16x32_bf16 v[44:47], v[76:79], v[80:83], v[44:47]
    ds_read_b128 v[120:123], v8 offset:1152
    v_mfma_f32_16x16x32_bf16 v[20:23], v[48:51], v[84:87], v[20:23]
    ds_read_b64 v[152:153], v9 offset:2688
    v_mfma_f32_16x16x32_bf16 v[24:27], v[52:55], v[84:87], v[24:27]
    ds_read_b64 v[154:155], v9 offset:2696
    v_mfma_f32_16x16x32_bf16 v[28:31], v[56:59], v[84:87], v[28:31]
    ds_read_b128 v[124:127], v8 offset:1664
    v_mfma_f32_16x16x32_bf16 v[32:35], v[60:63], v[84:87], v[32:35]
    ds_read_b64 v[156:157], v9 offset:2176
    v_mfma_f32_16x16x32_bf16 v[36:39], v[64:67], v[84:87], v[36:39]
    ds_read_b64 v[158:159], v9 offset:2184
    v_mfma_f32_16x16x32_bf16 v[40:43], v[68:71], v[84:87], v[40:43]
    v_mfma_f32_16x16x32_bf16 v[44:47], v[72:75], v[84:87], v[44:47]
    ds_read_b128 v[128:131], v8 offset:2176
    v_mfma_f32_16x16x32_bf16 v[24:27], v[48:51], v[88:91], v[24:27]
    ds_read_b64 v[160:161], v9 offset:1664
    v_mfma_f32_16x16x32_bf16 v[28:31], v[52:55], v[88:91], v[28:31]
    ds_read_b64 v[162:163], v9 offset:1672
    v_mfma_f32_16x16x32_bf16 v[32:35], v[56:59], v[88:91], v[32:35]
    ds_read_b128 v[132:135], v8 offset:2688
    v_mfma_f32_16x16x32_bf16 v[36:39], v[60:63], v[88:91], v[36:39]
    ds_read_b64 v[164:165], v9 offset:1152
    v_mfma_f32_16x16x32_bf16 v[40:43], v[64:67], v[88:91], v[40:43]
    ds_read_b64 v[166:167], v9 offset:1160
    v_mfma_f32_16x16x32_bf16 v[44:47], v[68:71], v[88:91], v[44:47]
    v_mfma_f32_16x16x32_bf16 v[28:31], v[48:51], v[92:95], v[28:31]
    ds_read_b128 v[136:139], v8 offset:3200
    v_mfma_f32_16x16x32_bf16 v[32:35], v[52:55], v[92:95], v[32:35]
    ds_read_b64 v[168:169], v9 offset:640
    v_mfma_f32_16x16x32_bf16 v[36:39], v[56:59], v[92:95], v[36:39]
    ds_read_b64 v[170:171], v9 offset:648
    v_mfma_f32_16x16x32_bf16 v[40:43], v[60:63], v[92:95], v[40:43]
    ds_read_b128 v[140:143], v8 offset:3712
    v_mfma_f32_16x16x32_bf16 v[44:47], v[64:67], v[92:95], v[44:47]
    ds_read_b64 v[172:173], v9 offset:128
    v_mfma_f32_16x16x32_bf16 v[32:35], v[48:51], v[96:99], v[32:35]
    ds_read_b64 v[174:175], v9 offset:136
    v_mfma_f32_16x16x32_bf16 v[36:39], v[52:55], v[96:99], v[36:39]
    v_mfma_f32_16x16x32_bf16 v[40:43], v[56:59], v[96:99], v[40:43]
    v_mfma_f32_16x16x32_bf16 v[44:47], v[60:63], v[96:99], v[44:47]
    v_mfma_f32_16x16x32_bf16 v[36:39], v[48:51], v[100:103], v[36:39]
    v_mfma_f32_16x16x32_bf16 v[40:43], v[52:55], v[100:103], v[40:43]
    v_mfma_f32_16x16x32_bf16 v[44:47], v[56:59], v[100:103], v[44:47]
    v_mfma_f32_16x16x32_bf16 v[40:43], v[48:51], v[104:107], v[40:43]
    v_mfma_f32_16x16x32_bf16 v[44:47], v[52:55], v[104:107], v[44:47]
    v_mfma_f32_16x16x32_bf16 v[44:47], v[48:51], v[108:111], v[44:47]
    s_waitcnt lgkmcnt(0)
    v_mfma_f32_16x16x32_bf16 v[16:19], v[112:115], v[144:147], v[16:19]
    ds_read_b128 v[48:51], v8 offset:64
    v_mfma_f32_16x16x32_bf16 v[20:23], v[116:119], v[144:147], v[20:23]
    ds_read_b64 v[80:81], v9 offset:3648
    v_mfma_f32_16x16x32_bf16 v[24:27], v[120:123], v[144:147], v[24:27]
    ds_read_b64 v[82:83], v9 offset:3656
    v_mfma_f32_16x16x32_bf16 v[28:31], v[124:127], v[144:147], v[28:31]
    ds_read_b128 v[52:55], v8 offset:576
    v_mfma_f32_16x16x32_bf16 v[32:35], v[128:131], v[144:147], v[32:35]
    ds_read_b64 v[84:85], v9 offset:3136
    v_mfma_f32_16x16x32_bf16 v[36:39], v[132:135], v[144:147], v[36:39]
    ds_read_b64 v[86:87], v9 offset:3144
    v_mfma_f32_16x16x32_bf16 v[40:43], v[136:139], v[144:147], v[40:43]
    v_mfma_f32_16x16x32_bf16 v[44:47], v[140:143], v[144:147], v[44:47]
    ds_read_b128 v[56:59], v8 offset:1088
    v_mfma_f32_16x16x32_bf16 v[20:23], v[112:115], v[148:151], v[20:23]
    ds_read_b64 v[88:89], v9 offset:2624
    v_mfma_f32_16x16x32_bf16 v[24:27], v[116:119], v[148:151], v[24:27]
    ds_read_b64 v[90:91], v9 offset:2632
    v_mfma_f32_16x16x32_bf16 v[28:31], v[120:123], v[148:151], v[28:31]
    ds_read_b128 v[60:63], v8 offset:1600
    v_mfma_f32_16x16x32_bf16 v[32:35], v[124:127], v[148:151], v[32:35]
    ds_read_b64 v[92:93], v9 offset:2112
    v_mfma_f32_16x16x32_bf16 v[36:39], v[128:131], v[148:151], v[36:39]
    ds_read_b64 v[94:95], v9 offset:2120
    v_mfma_f32_16x16x32_bf16 v[40:43], v[132:135], v[148:151], v[40:43]
    v_mfma_f32_16x16x32_bf16 v[44:47], v[136:139], v[148:151], v[44:47]
    ds_read_b128 v[64:67], v8 offset:2112
    v_mfma_f32_16x16x32_bf16 v[24:27], v[112:115], v[152:155], v[24:27]
    ds_read_b64 v[96:97], v9 offset:1600
    v_mfma_f32_16x16x32_bf16 v[28:31], v[116:119], v[152:155], v[28:31]
    ds_read_b64 v[98:99], v9 offset:1608
    v_mfma_f32_16x16x32_bf16 v[32:35], v[120:123], v[152:155], v[32:35]
    ds_read_b128 v[68:71], v8 offset:2624
    v_mfma_f32_16x16x32_bf16 v[36:39], v[124:127], v[152:155], v[36:39]
    ds_read_b64 v[100:101], v9 offset:1088
    v_mfma_f32_16x16x32_bf16 v[40:43], v[128:131], v[152:155], v[40:43]
    ds_read_b64 v[102:103], v9 offset:1096
    v_mfma_f32_16x16x32_bf16 v[44:47], v[132:135], v[152:155], v[44:47]
    v_mfma_f32_16x16x32_bf16 v[28:31], v[112:115], v[156:159], v[28:31]
    ds_read_b128 v[72:75], v8 offset:3136
    v_mfma_f32_16x16x32_bf16 v[32:35], v[116:119], v[156:159], v[32:35]
    ds_read_b64 v[104:105], v9 offset:576
    v_mfma_f32_16x16x32_bf16 v[36:39], v[120:123], v[156:159], v[36:39]
    ds_read_b64 v[106:107], v9 offset:584
    v_mfma_f32_16x16x32_bf16 v[40:43], v[124:127], v[156:159], v[40:43]
    ds_read_b128 v[76:79], v8 offset:3648
    v_mfma_f32_16x16x32_bf16 v[44:47], v[128:131], v[156:159], v[44:47]
    ds_read_b64 v[108:109], v9 offset:64
    v_mfma_f32_16x16x32_bf16 v[32:35], v[112:115], v[160:163], v[32:35]
    ds_read_b64 v[110:111], v9 offset:72
    v_mfma_f32_16x16x32_bf16 v[36:39], v[116:119], v[160:163], v[36:39]
    v_mfma_f32_16x16x32_bf16 v[40:43], v[120:123], v[160:163], v[40:43]
    v_mfma_f32_16x16x32_bf16 v[44:47], v[124:127], v[160:163], v[44:47]
    v_mfma_f32_16x16x32_bf16 v[36:39], v[112:115], v[164:167], v[36:39]
    v_mfma_f32_16x16x32_bf16 v[40:43], v[116:119], v[164:167], v[40:43]
    v_mfma_f32_16x16x32_bf16 v[44:47], v[120:123], v[164:167], v[44:47]
    v_mfma_f32_16x16x32_bf16 v[40:43], v[112:115], v[168:171], v[40:43]
    v_mfma_f32_16x16x32_bf16 v[44:47], v[116:119], v[168:171], v[44:47]
    v_mfma_f32_16x16x32_bf16 v[44:47], v[112:115], v[172:175], v[44:47]
    s_waitcnt lgkmcnt(0)
    v_mfma_f32_16x16x32_bf16 v[16:19], v[48:51], v[80:83], v[16:19]
    ds_read_b128 v[112:115], v8 offset:0
    v_mfma_f32_16x16x32_bf16 v[20:23], v[52:55], v[80:83], v[20:23]
    ds_read_b64 v[144:145], v9 offset:3584
    v_mfma_f32_16x16x32_bf16 v[24:27], v[56:59], v[80:83], v[24:27]
    ds_read_b64 v[146:147], v9 offset:3592
    v_mfma_f32_16x16x32_bf16 v[28:31], v[60:63], v[80:83], v[28:31]
    ds_read_b128 v[116:119], v8 offset:512
    v_mfma_f32_16x16x32_bf16 v[32:35], v[64:67], v[80:83], v[32:35]
    ds_read_b64 v[148:149], v9 offset:3072
    v_mfma_f32_16x16x32_bf16 v[36:39], v[68:71], v[80:83], v[36:39]
    ds_read_b64 v[150:151], v9 offset:3080
    v_mfma_f32_16x16x32_bf16 v[40:43], v[72:75], v[80:83], v[40:43]
    v_mfma_f32_16x16x32_bf16 v[44:47], v[76:79], v[80:83], v[44:47]
    ds_read_b128 v[120:123], v8 offset:1024
    v_mfma_f32_16x16x32_bf16 v[20:23], v[48:51], v[84:87], v[20:23]
    ds_read_b64 v[152:153], v9 offset:2560
    v_mfma_f32_16x16x32_bf16 v[24:27], v[52:55], v[84:87], v[24:27]
    ds_read_b64 v[154:155], v9 offset:2568
    v_mfma_f32_16x16x32_bf16 v[28:31], v[56:59], v[84:87], v[28:31]
    ds_read_b128 v[124:127], v8 offset:1536
    v_mfma_f32_16x16x32_bf16 v[32:35], v[60:63], v[84:87], v[32:35]
    ds_read_b64 v[156:157], v9 offset:2048
    v_mfma_f32_16x16x32_bf16 v[36:39], v[64:67], v[84:87], v[36:39]
    ds_read_b64 v[158:159], v9 offset:2056
    v_mfma_f32_16x16x32_bf16 v[40:43], v[68:71], v[84:87], v[40:43]
    v_mfma_f32_16x16x32_bf16 v[44:47], v[72:75], v[84:87], v[44:47]
    ds_read_b128 v[128:131], v8 offset:2048
    v_mfma_f32_16x16x32_bf16 v[24:27], v[48:51], v[88:91], v[24:27]
    ds_read_b64 v[160:161], v9 offset:1536
    v_mfma_f32_16x16x32_bf16 v[28:31], v[52:55], v[88:91], v[28:31]
    ds_read_b64 v[162:163], v9 offset:1544
    v_mfma_f32_16x16x32_bf16 v[32:35], v[56:59], v[88:91], v[32:35]
    ds_read_b128 v[132:135], v8 offset:2560
    v_mfma_f32_16x16x32_bf16 v[36:39], v[60:63], v[88:91], v[36:39]
    ds_read_b64 v[164:165], v9 offset:1024
    v_mfma_f32_16x16x32_bf16 v[40:43], v[64:67], v[88:91], v[40:43]
    ds_read_b64 v[166:167], v9 offset:1032
    v_mfma_f32_16x16x32_bf16 v[44:47], v[68:71], v[88:91], v[44:47]
    v_mfma_f32_16x16x32_bf16 v[28:31], v[48:51], v[92:95], v[28:31]
    ds_read_b128 v[136:139], v8 offset:3072
    v_mfma_f32_16x16x32_bf16 v[32:35], v[52:55], v[92:95], v[32:35]
    ds_read_b64 v[168:169], v9 offset:512
    v_mfma_f32_16x16x32_bf16 v[36:39], v[56:59], v[92:95], v[36:39]
    ds_read_b64 v[170:171], v9 offset:520
    v_mfma_f32_16x16x32_bf16 v[40:43], v[60:63], v[92:95], v[40:43]
    ds_read_b128 v[140:143], v8 offset:3584
    v_mfma_f32_16x16x32_bf16 v[44:47], v[64:67], v[92:95], v[44:47]
    ds_read_b64 v[172:173], v9 offset:0
    v_mfma_f32_16x16x32_bf16 v[32:35], v[48:51], v[96:99], v[32:35]
    ds_read_b64 v[174:175], v9 offset:8
    v_mfma_f32_16x16x32_bf16 v[36:39], v[52:55], v[96:99], v[36:39]
    v_mfma_f32_16x16x32_bf16 v[40:43], v[56:59], v[96:99], v[40:43]
    v_mfma_f32_16x16x32_bf16 v[44:47], v[60:63], v[96:99], v[44:47]
    v_mfma_f32_16x16x32_bf16 v[36:39], v[48:51], v[100:103], v[36:39]
    v_mfma_f32_16x16x32_bf16 v[40:43], v[52:55], v[100:103], v[40:43]
    v_mfma_f32_16x16x32_bf16 v[44:47], v[56:59], v[100:103], v[44:47]
    v_mfma_f32_16x16x32_bf16 v[40:43], v[48:51], v[104:107], v[40:43]
    v_mfma_f32_16x16x32_bf16 v[44:47], v[52:55], v[104:107], v[44:47]
    v_mfma_f32_16x16x32_bf16 v[44:47], v[48:51], v[108:111], v[44:47]
    s_waitcnt lgkmcnt(0)
    v_mfma_f32_16x16x32_bf16 v[16:19], v[112:115], v[144:147], v[16:19]
    v_mfma_f32_16x16x32_bf16 v[20:23], v[116:119], v[144:147], v[20:23]
    v_mfma_f32_16x16x32_bf16 v[24:27], v[120:123], v[144:147], v[24:27]
    v_mfma_f32_16x16x32_bf16 v[28:31], v[124:127], v[144:147], v[28:31]
    v_mfma_f32_16x16x32_bf16 v[32:35], v[128:131], v[144:147], v[32:35]
    v_mfma_f32_16x16x32_bf16 v[36:39], v[132:135], v[144:147], v[36:39]
    v_mfma_f32_16x16x32_bf16 v[40:43], v[136:139], v[144:147], v[40:43]
    v_mfma_f32_16x16x32_bf16 v[44:47], v[140:143], v[144:147], v[44:47]
    v_mfma_f32_16x16x32_bf16 v[20:23], v[112:115], v[148:151], v[20:23]
    v_mfma_f32_16x16x32_bf16 v[24:27], v[116:119], v[148:151], v[24:27]
    v_mfma_f32_16x16x32_bf16 v[28:31], v[120:123], v[148:151], v[28:31]
    v_mfma_f32_16x16x32_bf16 v[32:35], v[124:127], v[148:151], v[32:35]
    v_mfma_f32_16x16x32_bf16 v[36:39], v[128:131], v[148:151], v[36:39]
    v_mfma_f32_16x16x32_bf16 v[40:43], v[132:135], v[148:151], v[40:43]
    v_mfma_f32_16x16x32_bf16 v[44:47], v[136:139], v[148:151], v[44:47]
    v_mfma_f32_16x16x32_bf16 v[24:27], v[112:115], v[152:155], v[24:27]
    v_mfma_f32_16x16x32_bf16 v[28:31], v[116:119], v[152:155], v[28:31]
    v_mfma_f32_16x16x32_bf16 v[32:35], v[120:123], v[152:155], v[32:35]
    v_mfma_f32_16x16x32_bf16 v[36:39], v[124:127], v[152:155], v[36:39]
    v_mfma_f32_16x16x32_bf16 v[40:43], v[128:131], v[152:155], v[40:43]
    v_mfma_f32_16x16x32_bf16 v[44:47], v[132:135], v[152:155], v[44:47]
    v_mfma_f32_16x16x32_bf16 v[28:31], v[112:115], v[156:159], v[28:31]
    v_mfma_f32_16x16x32_bf16 v[32:35], v[116:119], v[156:159], v[32:35]
    v_mfma_f32_16x16x32_bf16 v[36:39], v[120:123], v[156:159], v[36:39]
    v_mfma_f32_16x16x32_bf16 v[40:43], v[124:127], v[156:159], v[40:43]
    v_mfma_f32_16x16x32_bf16 v[44:47], v[128:131], v[156:159], v[44:47]
    v_mfma_f32_16x16x32_bf16 v[32:35], v[112:115], v[160:163], v[32:35]
    v_mfma_f32_16x16x32_bf16 v[36:39], v[116:119], v[160:163], v[36:39]
    v_mfma_f32_16x16x32_bf16 v[40:43], v[120:123], v[160:163], v[40:43]
    v_mfma_f32_16x16x32_bf16 v[44:47], v[124:127], v[160:163], v[44:47]
    v_mfma_f32_16x16x32_bf16 v[36:39], v[112:115], v[164:167], v[36:39]
    v_mfma_f32_16x16x32_bf16 v[40:43], v[116:119], v[164:167], v[40:43]
    v_mfma_f32_16x16x32_bf16 v[44:47], v[120:123], v[164:167], v[44:47]
    v_mfma_f32_16x16x32_bf16 v[40:43], v[112:115], v[168:171], v[40:43]
    v_mfma_f32_16x16x32_bf16 v[44:47], v[116:119], v[168:171], v[44:47]
    v_mfma_f32_16x16x32_bf16 v[44:47], v[112:115], v[172:175], v[44:47]
    s_mul_i32 s67, s50, 4224
    s_add_u32 s67, s67, 11534336
    s_nop 7
    v_cvt_pk_bf16_f32 v48, v16, v17
    v_cvt_pk_bf16_f32 v49, v18, v19
    buffer_store_dwordx2 v[48:49], v10, s[20:23], s67 offen offset:0 sc1
    v_cvt_pk_bf16_f32 v50, v20, v21
    v_cvt_pk_bf16_f32 v51, v22, v23
    buffer_store_dwordx2 v[50:51], v10, s[20:23], s67 offen offset:512 sc1
    v_cvt_pk_bf16_f32 v52, v24, v25
    v_cvt_pk_bf16_f32 v53, v26, v27
    buffer_store_dwordx2 v[52:53], v10, s[20:23], s67 offen offset:1024 sc1
    v_cvt_pk_bf16_f32 v54, v28, v29
    v_cvt_pk_bf16_f32 v55, v30, v31
    buffer_store_dwordx2 v[54:55], v10, s[20:23], s67 offen offset:1536 sc1
    v_cvt_pk_bf16_f32 v56, v32, v33
    v_cvt_pk_bf16_f32 v57, v34, v35
    buffer_store_dwordx2 v[56:57], v10, s[20:23], s67 offen offset:2048 sc1
    v_cvt_pk_bf16_f32 v58, v36, v37
    v_cvt_pk_bf16_f32 v59, v38, v39
    buffer_store_dwordx2 v[58:59], v10, s[20:23], s67 offen offset:2560 sc1
    v_cvt_pk_bf16_f32 v60, v40, v41
    v_cvt_pk_bf16_f32 v61, v42, v43
    buffer_store_dwordx2 v[60:61], v10, s[20:23], s67 offen offset:3072 sc1
    v_cvt_pk_bf16_f32 v62, v44, v45
    v_cvt_pk_bf16_f32 v63, v46, v47
    buffer_store_dwordx2 v[62:63], v10, s[20:23], s67 offen offset:3584 sc1
    s_setprio 0
    s_waitcnt vmcnt(0)
    v_mov_b32 v4, 161664
    ds_read_b32 v4, v4
    s_waitcnt lgkmcnt(0)
    v_readfirstlane_b32 s64, v4
    s_nop 1
    s_lshl_b32 s69, s50, 2
    s_add_u32 s69, s69, 14753792
    v_mov_b32 v2, s64
    v_mov_b32 v3, 0
    s_mov_b64 exec, 1
    buffer_store_dword v2, v3, s[20:23], s69 offen sc1
    s_mov_b64 exec, -1
gated_mix__ssm_conv_s4__swiglu_ffn__prompt_kernel_ssm_done:
    s_cmp_lg_u32 s3, 7
    s_cbranch_scc1 L_gated__fin_40
    v_mov_b32 v2, 161688
    s_mov_b32 s69, 0
L_gated__ls_41:
    ds_read_b32 v3, v2
    s_waitcnt lgkmcnt(0)
    v_readfirstlane_b32 s78, v3
    s_nop 1
    s_cmp_eq_u32 s78, 4
    s_cbranch_scc1 L_gated__ld_42
    s_add_u32 s69, s69, 1
    s_cmp_lt_u32 s69, 0x400000
    s_cbranch_scc0 L_gated__ld_42
    s_sleep 1
    s_branch L_gated__ls_41
L_gated__ld_42:
    v_mbcnt_lo_u32_b32 v0, -1, 0
    v_mbcnt_hi_u32_b32 v0, -1, v0
    s_mul_i32 s67, s7, 320
    s_add_u32 s67, s67, 14753792
    v_lshl_add_u32 v1, v0, 2, s67
    v_add_u32 v2, 256, v1
    s_lshl_b32 s68, s6, 5
    s_add_u32 s68, s68, 14761920
    v_lshl_add_u32 v3, v0, 2, s68
    v_cmp_le_u32 vcc, 16, v0
    s_nop 1
    v_cndmask_b32 v2, v2, v3, vcc
    v_subrev_u32 v3, 24, v0
    v_lshlrev_b32 v3, 10, v3
    s_lshl_b32 s68, s2, 2
    s_add_u32 s68, s68, 14753792
    v_add_u32 v3, s68, v3
    v_cmp_le_u32 vcc, 24, v0
    s_nop 1
    v_cndmask_b32 v2, v2, v3, vcc
    s_cmp_lt_u32 s2, 128
    s_cselect_b32 s68, 27, 26
    v_mov_b32 v3, s67
    v_cmp_le_u32 vcc, s68, v0
    s_nop 1
    v_cndmask_b32 v2, v2, v3, vcc
    s_mov_b32 s69, 0
L_gated__pl_43:
    buffer_load_dword v4, v1, s[20:23], 0 offen sc1
    buffer_load_dword v5, v2, s[20:23], 0 offen sc1
    s_waitcnt vmcnt(0)
    v_cmp_eq_u32 vcc, s64, v4
    v_cmp_eq_u32 s[76:77], s64, v5
    s_nop 1
    s_and_b64 vcc, vcc, s[76:77]
    s_nop 1
    s_cmp_eq_u64 vcc, -1
    s_cbranch_scc1 L_gated__pd_44
    s_add_u32 s69, s69, 1
    s_cmp_lt_u32 s69, 0x40000
    s_cbranch_scc0 L_gated__pd_44
    s_sleep 8
    s_branch L_gated__pl_43
L_gated__pd_44:
    v_mbcnt_lo_u32_b32 v0, -1, 0
    v_mbcnt_hi_u32_b32 v0, -1, v0
    v_lshrrev_b32 v1, 3, v0
    v_mul_u32_u24 v1, 4224, v1
    v_and_b32 v2, 7, v0
    v_lshl_add_u32 v1, v2, 4, v1
    s_mul_i32 s67, s7, 337920
    s_lshl_b32 s68, s6, 7
    s_add_u32 s67, s67, s68
    s_add_u32 s67, s67, 11534336
    buffer_load_dwordx4 v[8:11], v1, s[20:23], s67 offen sc1
    s_add_u32 s67, s67, 33792
    buffer_load_dwordx4 v[12:15], v1, s[20:23], s67 offen sc1
    s_add_u32 s67, s67, 33792
    buffer_load_dwordx4 v[16:19], v1, s[20:23], s67 offen sc1
    s_add_u32 s67, s67, 33792
    buffer_load_dwordx4 v[20:23], v1, s[20:23], s67 offen sc1
    s_add_u32 s67, s67, 33792
    buffer_load_dwordx4 v[24:27], v1, s[20:23], s67 offen sc1
    s_add_u32 s67, s67, 33792
    buffer_load_dwordx4 v[28:31], v1, s[20:23], s67 offen sc1
    s_add_u32 s67, s67, 33792
    buffer_load_dwordx4 v[32:35], v1, s[20:23], s67 offen sc1
    s_add_u32 s67, s67, 33792
    buffer_load_dwordx4 v[36:39], v1, s[20:23], s67 offen sc1
    s_add_u32 s67, s67, 33792
    buffer_load_dwordx4 v[40:43], v1, s[20:23], s67 offen sc1
    s_add_u32 s67, s67, 33792
    buffer_load_dwordx4 v[44:47], v1, s[20:23], s67 offen sc1
    s_lshl_b32 s67, s6, 8
    s_add_u32 s67, s67, 14680064
    v_lshlrev_b32 v3, 2, v0
    buffer_load_dword v4, v3, s[20:23], s67 offen sc1
    v_mov_b32 v59, 0
    s_cmp_lg_u32 s2, 0
    s_cbranch_scc1 L_gated__nl_45
    v_lshlrev_b32 v59, 4, v0
    s_mov_b32 s78, 14761984
    buffer_load_dwordx4 v[60:63], v59, s[20:23], s78 offen sc1
L_gated__nl_45:
    v_lshlrev_b32 v2, 4, v0
    v_add_u32 v2, 122880, v2
    v_add_u32 v3, 161728, v3
    s_waitcnt vmcnt(0)
    ds_write_b128 v2, v[8:11] offset:0
    ds_write_b128 v2, v[12:15] offset:1024
    ds_write_b128 v2, v[16:19] offset:2048
    ds_write_b128 v2, v[20:23] offset:3072
    ds_write_b128 v2, v[24:27] offset:4096
    ds_write_b128 v2, v[28:31] offset:5120
    ds_write_b128 v2, v[32:35] offset:6144
    ds_write_b128 v2, v[36:39] offset:7168
    ds_write_b128 v2, v[40:43] offset:8192
    ds_write_b128 v2, v[44:47] offset:9216
    ds_write_b32 v3, v4
    s_waitcnt lgkmcnt(0)
    s_barrier
    s_cmp_lg_u32 s2, 0
    s_cbranch_scc1 L_gated__nu_46
    v_cmp_eq_u32 vcc, s64, v60
    v_cmp_eq_u32 s[76:77], s64, v61
    s_nop 1
    s_and_b64 vcc, vcc, s[76:77]
    v_cmp_eq_u32 s[76:77], s64, v62
    s_nop 1
    s_and_b64 vcc, vcc, s[76:77]
    v_cmp_eq_u32 s[76:77], s64, v63
    s_nop 1
    s_and_b64 vcc, vcc, s[76:77]
    s_nop 1
    s_cmp_eq_u64 vcc, -1
    s_cbranch_scc1 L_gated__nu_47
    v_mbcnt_lo_u32_b32 v2, -1, 0
    v_mbcnt_hi_u32_b32 v2, -1, v2
    v_lshlrev_b32 v2, 4, v2
    s_mov_b32 s78, 14761984
    s_mov_b32 s69, 0
L_gated__pl_48:
    buffer_load_dwordx4 v[4:7], v2, s[20:23], s78 offen sc1
    s_waitcnt vmcnt(0)
    v_cmp_eq_u32 vcc, s64, v4
    v_cmp_eq_u32 s[76:77], s64, v5
    s_nop 1
    s_and_b64 vcc, vcc, s[76:77]
    v_cmp_eq_u32 s[76:77], s64, v6
    s_nop 1
    s_and_b64 vcc, vcc, s[76:77]
    v_cmp_eq_u32 s[76:77], s64, v7
    s_nop 1
    s_and_b64 vcc, vcc, s[76:77]
    s_nop 1
    s_cmp_eq_u64 vcc, -1
    s_cbranch_scc1 L_gated__pd_49
    s_add_u32 s69, s69, 1
    s_cmp_lt_u32 s69, 0x40000
    s_cbranch_scc0 L_gated__pd_49
    s_sleep 8
    s_branch L_gated__pl_48
L_gated__pd_49:
L_gated__nu_47:
    s_mov_b32 s69, 14757888
    v_mov_b32 v2, s64
    v_mov_b32 v3, 0
    s_mov_b64 exec, 1
    buffer_store_dword v2, v3, s[20:23], s69 offen sc1
    s_mov_b64 exec, -1
L_gated__nu_46:
    s_branch L_gated__fin_40_fd
L_gated__fin_40:
    s_barrier
L_gated__fin_40_fd:
gated_mix__ssm_conv_s4__swiglu_ffn__prompt_kernel_end:
    s_endpgm
.section .rodata,"a"
.p2align 6
.amdhsa_kernel gated_mix__ssm_conv_s4__swiglu_ffn__prompt_kernel
  .amdhsa_next_free_vgpr 256
  .amdhsa_next_free_sgpr 102
  .amdhsa_accum_offset 256
  .amdhsa_group_segment_fixed_size 0
  .amdhsa_kernarg_size 136
  .amdhsa_user_sgpr_count 2
  .amdhsa_user_sgpr_kernarg_segment_ptr 1
  .amdhsa_system_sgpr_workgroup_id_x 1
.end_amdhsa_kernel
```
